```python
import torch

def _softmax(x, axis=-1):
    return torch.softmax(x, dim=axis)
def _gelu(x):
    return torch.nn.functional.gelu(x, approximate="tanh")
def _silu(x):
    return torch.nn.functional.silu(x)
def _sigmoid(x):
    return torch.sigmoid(x)
def _layernorm(x, axis=-1, eps=1e-5):
    m = x.mean(dim=axis, keepdim=True)
    v = x.var(dim=axis, keepdim=True, unbiased=False)
    return (x - m) / torch.sqrt(v + eps)
def _scatter_add(tgt, idx, src, axis=0):
    return tgt.clone().index_add_(axis, idx, src)
def _segment_sum(src, seg, n):
    out = torch.zeros((n,) + src.shape[1:], dtype=src.dtype)
    return out.index_add_(0, seg, src)
def _pad(x, pw):
    flat = tuple(v for pair in reversed(pw) for v in pair)
    return torch.nn.functional.pad(x, flat)

kernel_name = 'standalone__fused_io_aware_attn__prompt'

def setup_inputs():

    _w = (lambda a: (lambda t: t.to(torch.bfloat16) if t.is_floating_point() else t)(torch.as_tensor(a)))
    B, H, S = 2, 32, 2048
    Dh = max(1, 1024 // 32)
    return {
        "q": _w((lambda *s: torch.randn(*s, dtype=torch.bfloat16) * 0.8)(B, H, S, Dh)),
        "k": _w((lambda *s: torch.randn(*s, dtype=torch.bfloat16) * 0.8)(B, H, S, Dh)),
        "v": _w((lambda *s: torch.randn(*s, dtype=torch.bfloat16) * 0.05)(B, H, S, Dh)),
    }

def reference(q, k, v):
    scale = q.shape[-1] ** -0.5
    s = torch.einsum('bhqd,bhkd->bhqk', q, k) * scale
    p = _softmax(s, axis=-1)
    return torch.einsum('bhqk,bhkd->bhqd', p, v)
```

```asm
; @launch grid=(256,1,1) block=(320,1,1) lds=141312
.amdgcn_target "amdgcn-amd-amdhsa--gfx950"
.text
.globl standalone__fused_io_aware_attn__prompt_kernel
.p2align 8
.type standalone__fused_io_aware_attn__prompt_kernel,@function
standalone__fused_io_aware_attn__prompt_kernel:
    s_lshr_b32 s3, s2, 8
    s_cbranch_scc1 L_end
    s_load_dwordx4 s[4:7], s[0:1], 0
    s_load_dwordx4 s[8:11], s[0:1], 16
    s_getpc_b64 s[42:43]
    v_lshlrev_b32 v252, 5, v0
    global_load_dword v16, v252, s[42:43]
    s_and_b32 s34, s2, 7
    s_lshl_b32 s34, s34, 20
    s_lshr_b32 s36, s2, 3
    s_lshl_b32 s36, s36, 15
    s_or_b32 s36, s36, s34
    v_and_b32 v252, 31, v0
    v_lshlrev_b32 v249, 6, v252
    v_bfe_u32 v254, v0, 5, 1
    v_lshl_or_b32 v249, v254, 4, v249
    v_lshrrev_b32 v252, 6, v0
    v_lshl_add_u32 v255, v252, 13, v249
    v_readfirstlane_b32 s28, v252
    v_add_u32 v255, s36, v255
    s_cmp_eq_u32 s28, 4
    s_cbranch_scc1 L_helper
    s_waitcnt lgkmcnt(0)
    global_load_dwordx4 v[160:163], v255, s[4:5] offset:0 nt
    global_load_dwordx4 v[164:167], v255, s[4:5] offset:32 nt
    global_load_dwordx4 v[168:171], v255, s[4:5] offset:2048 nt
    global_load_dwordx4 v[172:175], v255, s[4:5] offset:2080 nt
    s_barrier
    s_branch L_compute2
L_helper:
    v_and_b32 v253, 63, v0
    s_and_b32 s34, s36, 0xfffe0000
    v_lshlrev_b32 v246, 4, v253
    v_add_u32 v248, 32, v249
    s_mov_b32 s14, 131072
    s_mov_b32 s15, 0x00020000
    s_mov_b32 s18, 131072
    s_mov_b32 s19, 0x00020000
    s_mov_b32 s32, 0
    s_waitcnt lgkmcnt(0)
    s_add_u32 s12, s6, s34
    s_addc_u32 s13, s7, 0
    s_add_u32 s16, s8, s34
    s_addc_u32 s17, s9, 0
    s_call_b64 s[38:39], L_issue
    s_branch L_h2
L_issue:
    s_and_b32 s33, s32, 28
    s_lshl_b32 s33, s33, 12
    s_and_b32 s34, s32, 3
    s_lshl_b32 s34, s34, 11
    s_add_u32 s33, s33, s34
    s_add_u32 s33, s33, 2048
    s_mov_b32 m0, s33
    s_and_b32 s35, s32, 63
    s_lshl_b32 s35, s35, 11
    buffer_load_dwordx4 v249, s[12:15], s35 offen lds
    s_add_u32 s34, s33, 1024
    s_mov_b32 m0, s34
    s_add_u32 s34, s33, 8192
    buffer_load_dwordx4 v248, s[12:15], s35 offen lds
    s_mov_b32 m0, s34
    s_add_u32 s32, s32, 1
    buffer_load_dwordx4 v246, s[16:19], s35 offen lds
    buffer_load_dwordx4 v246, s[16:19], s35 offen offset:1024 lds
    s_setpc_b64 s[38:39]
L_h2:
    v_mov_b32 v8, 0
    v_mov_b32 v9, 0
    v_mov_b32 v10, 0
    v_mov_b32 v11, 0
    ds_write_b128 v246, v[8:11]
    ds_write_b128 v246, v[8:11] offset:1024
    s_call_b64 s[38:39], L_issue
    s_waitcnt lgkmcnt(0)
    s_barrier
    s_call_b64 s[38:39], L_issue
    s_call_b64 s[38:39], L_issue
    v_and_b32 v13, 3, v253
    v_lshlrev_b32 v12, 8, v13
    v_mov_b32 v14, 1
    v_mov_b32 v5, 7
    v_mov_b32 v6, 4
    s_mov_b32 s3, 0x40000
    s_waitcnt vmcnt(12)
    ds_add_u32 v246, v14
    s_call_b64 s[38:39], L_issue
    s_call_b64 s[38:39], L_issue
    s_waitcnt vmcnt(16)
    ds_add_u32 v246, v14
    s_call_b64 s[38:39], L_issue
    s_call_b64 s[38:39], L_issue
    s_waitcnt vmcnt(20)
    ds_add_u32 v246, v14
    s_call_b64 s[38:39], L_issue
    s_call_b64 s[38:39], L_issue
    s_waitcnt vmcnt(24)
    ds_add_u32 v246, v14
    s_call_b64 s[38:39], L_issue
    s_call_b64 s[38:39], L_issue
L_hph1:
    s_waitcnt vmcnt(28)
    ds_add_u32 v246, v14
    s_cmp_lt_u32 s32, 20
    s_cbranch_scc0 L_hdrain
    s_call_b64 s[38:39], L_issue
    s_branch L_hph1
L_hdrain:
    s_waitcnt vmcnt(0)
    ds_add_u32 v246, v5
L_hchunk:
    s_lshr_b32 s36, s32, 2
    s_sub_u32 s36, s36, 4
    s_mul_i32 s36, s36, 56797
L_hpoll:
    ds_read_b32 v13, v12 offset:1024
    s_waitcnt lgkmcnt(0)
    s_setprio 3
    v_cmp_gt_u32 vcc, s36, v13
    s_setprio 0
    s_nop 0
    s_cmp_eq_u64 vcc, 0
    s_cbranch_scc1 L_hgo
    s_sleep 12
    s_sub_u32 s3, s3, 1
    s_cbranch_scc0 L_hpoll
    s_endpgm
L_hgo:
    s_call_b64 s[38:39], L_issue
    s_call_b64 s[38:39], L_issue
    s_call_b64 s[38:39], L_issue
    s_call_b64 s[38:39], L_issue
    s_waitcnt vmcnt(0)
    ds_add_u32 v246, v6
    s_cmp_lt_u32 s32, 68
    s_cbranch_scc1 L_hchunk
    s_waitcnt lgkmcnt(0)
    s_endpgm
L_poll_sleep:
    s_sub_u32 s3, s3, 1
    s_cbranch_scc1 L_end
    s_sleep 1
L_poll:
    ds_read_b32 v248, v246
    s_waitcnt lgkmcnt(0)
    v_readfirstlane_b32 s34, v248
    s_nop 0
    s_cmp_ge_u32 s34, s37
    s_cbranch_scc0 L_poll_sleep
    s_setpc_b64 s[38:39]
L_compute2:
    v_and_b32 v253, 63, v0
    s_and_b32 s34, s36, 0xfffe0000
    s_lshl_b32 s35, s28, 13
    s_add_u32 s36, s36, s35
    s_add_u32 s20, s4, s36
    s_addc_u32 s21, s5, 0
    s_mov_b32 s22, 8192
    s_mov_b32 s23, 0x00020000
    s_add_u32 s12, s6, s34
    s_addc_u32 s13, s7, 0
    s_add_u32 s16, s8, s34
    s_addc_u32 s17, s9, 0
    s_add_u32 s24, s10, s36
    s_addc_u32 s25, s11, 0
    s_mov_b32 s14, 131072
    s_mov_b32 s15, 0x00020000
    s_mov_b32 s18, 131072
    s_mov_b32 s19, 0x00020000
    s_mov_b32 s26, 8192
    s_mov_b32 s27, 0x00020000
    s_mov_b32 s3, 0x40000
    s_mov_b32 s41, 4096
    s_lshl_b32 s34, s28, 8
    s_add_u32 s34, s34, 1024
    v_lshlrev_b32 v246, 4, v253
    v_lshlrev_b32 v247, 2, v253
    v_add_u32 v247, s34, v247
    v_mov_b32 v245, v246
    v_and_b32 v252, 15, v253
    v_lshrrev_b32 v252, 2, v252
    v_lshl_add_u32 v252, v254, 3, v252
    v_lshlrev_b32 v252, 6, v252
    v_lshrrev_b32 v255, 4, v253
    v_and_b32 v255, 1, v255
    v_lshl_add_u32 v252, v255, 5, v252
    v_and_b32 v255, 3, v253
    v_lshl_add_u32 v252, v255, 3, v252
    v_add_u32 v251, 10240, v252
    v_mov_b32 v250, v251
    v_mov_b32 v255, 0x3f803f80
    v_mov_b32 v244, 0xdddd
    v_and_b32 v254, 15, v253
    v_cmp_eq_u32 vcc, 0, v254
    v_cmp_eq_u32 s[38:39], 4, v254
    s_nop 0
    v_cndmask_b32 v240, 0, v255, vcc
    v_cndmask_b32 v241, 0, v255, vcc
    v_cndmask_b32 v242, 0, v255, s[38:39]
    v_cndmask_b32 v243, 0, v255, s[38:39]
    v_pk_mov_b32 v[96:97], 0, 0
    v_pk_mov_b32 v[98:99], 0, 0
    v_pk_mov_b32 v[100:101], 0, 0
    v_pk_mov_b32 v[102:103], 0, 0
    v_pk_mov_b32 v[104:105], 0, 0
    v_pk_mov_b32 v[106:107], 0, 0
    v_pk_mov_b32 v[108:109], 0, 0
    v_pk_mov_b32 v[110:111], 0, 0
    v_pk_mov_b32 v[224:225], 0, 0
    v_pk_mov_b32 v[226:227], 0, 0
    v_pk_mov_b32 v[112:113], 0, 0
    v_pk_mov_b32 v[114:115], 0, 0
    v_pk_mov_b32 v[116:117], 0, 0
    v_pk_mov_b32 v[118:119], 0, 0
    v_pk_mov_b32 v[120:121], 0, 0
    v_pk_mov_b32 v[122:123], 0, 0
    v_pk_mov_b32 v[124:125], 0, 0
    v_pk_mov_b32 v[126:127], 0, 0
    v_pk_mov_b32 v[228:229], 0, 0
    v_pk_mov_b32 v[230:231], 0, 0
    v_pk_mov_b32 v[128:129], 0, 0
    v_pk_mov_b32 v[130:131], 0, 0
    v_pk_mov_b32 v[132:133], 0, 0
    v_pk_mov_b32 v[134:135], 0, 0
    v_pk_mov_b32 v[136:137], 0, 0
    v_pk_mov_b32 v[138:139], 0, 0
    v_pk_mov_b32 v[140:141], 0, 0
    v_pk_mov_b32 v[142:143], 0, 0
    v_pk_mov_b32 v[232:233], 0, 0
    v_pk_mov_b32 v[234:235], 0, 0
    v_pk_mov_b32 v[144:145], 0, 0
    v_pk_mov_b32 v[146:147], 0, 0
    v_pk_mov_b32 v[148:149], 0, 0
    v_pk_mov_b32 v[150:151], 0, 0
    v_pk_mov_b32 v[152:153], 0, 0
    v_pk_mov_b32 v[154:155], 0, 0
    v_pk_mov_b32 v[156:157], 0, 0
    v_pk_mov_b32 v[158:159], 0, 0
    v_pk_mov_b32 v[236:237], 0, 0
    v_pk_mov_b32 v[238:239], 0, 0
    s_mov_b32 s46, 0x3e8293ee
    s_mov_b32 s47, 0x3e8293ee
    s_mov_b32 s32, 0
    s_mov_b32 s37, 1
    s_mov_b32 s40, 0
    s_waitcnt vmcnt(0)
    ds_read_b32 v248, v246
    buffer_load_dwordx4 v[176:179], v249, s[20:23], s41 offen offset:0 nt
    buffer_load_dwordx4 v[180:183], v249, s[20:23], s41 offen offset:32 nt
    buffer_load_dwordx4 v[184:187], v249, s[20:23], s41 offen offset:2048 nt
    buffer_load_dwordx4 v[188:191], v249, s[20:23], s41 offen offset:2080 nt
    v_lshlrev_b32 v252, 16, v160
    v_and_b32 v253, 0xffff0000, v160
    v_pk_mul_f32 v[252:253], v[252:253], s[46:47]
    v_cvt_pk_bf16_f32 v160, v252, v253
    v_lshlrev_b32 v254, 16, v161
    v_and_b32 v255, 0xffff0000, v161
    v_pk_mul_f32 v[254:255], v[254:255], s[46:47]
    v_cvt_pk_bf16_f32 v161, v254, v255
    v_lshlrev_b32 v252, 16, v162
    v_and_b32 v253, 0xffff0000, v162
    v_pk_mul_f32 v[252:253], v[252:253], s[46:47]
    v_cvt_pk_bf16_f32 v162, v252, v253
    v_lshlrev_b32 v254, 16, v163
    v_and_b32 v255, 0xffff0000, v163
    v_pk_mul_f32 v[254:255], v[254:255], s[46:47]
    v_cvt_pk_bf16_f32 v163, v254, v255
    v_lshlrev_b32 v252, 16, v164
    v_and_b32 v253, 0xffff0000, v164
    v_pk_mul_f32 v[252:253], v[252:253], s[46:47]
    v_cvt_pk_bf16_f32 v164, v252, v253
    v_lshlrev_b32 v254, 16, v165
    v_and_b32 v255, 0xffff0000, v165
    v_pk_mul_f32 v[254:255], v[254:255], s[46:47]
    v_cvt_pk_bf16_f32 v165, v254, v255
    v_lshlrev_b32 v252, 16, v166
    v_and_b32 v253, 0xffff0000, v166
    v_pk_mul_f32 v[252:253], v[252:253], s[46:47]
    v_cvt_pk_bf16_f32 v166, v252, v253
    v_lshlrev_b32 v254, 16, v167
    v_and_b32 v255, 0xffff0000, v167
    v_pk_mul_f32 v[254:255], v[254:255], s[46:47]
    v_cvt_pk_bf16_f32 v167, v254, v255
    v_lshlrev_b32 v252, 16, v168
    v_and_b32 v253, 0xffff0000, v168
    v_pk_mul_f32 v[252:253], v[252:253], s[46:47]
    v_cvt_pk_bf16_f32 v168, v252, v253
    v_lshlrev_b32 v254, 16, v169
    v_and_b32 v255, 0xffff0000, v169
    v_pk_mul_f32 v[254:255], v[254:255], s[46:47]
    v_cvt_pk_bf16_f32 v169, v254, v255
    v_lshlrev_b32 v252, 16, v170
    v_and_b32 v253, 0xffff0000, v170
    v_pk_mul_f32 v[252:253], v[252:253], s[46:47]
    v_cvt_pk_bf16_f32 v170, v252, v253
    v_lshlrev_b32 v254, 16, v171
    v_and_b32 v255, 0xffff0000, v171
    v_pk_mul_f32 v[254:255], v[254:255], s[46:47]
    v_cvt_pk_bf16_f32 v171, v254, v255
    v_lshlrev_b32 v252, 16, v172
    v_and_b32 v253, 0xffff0000, v172
    v_pk_mul_f32 v[252:253], v[252:253], s[46:47]
    v_cvt_pk_bf16_f32 v172, v252, v253
    v_lshlrev_b32 v254, 16, v173
    v_and_b32 v255, 0xffff0000, v173
    v_pk_mul_f32 v[254:255], v[254:255], s[46:47]
    v_cvt_pk_bf16_f32 v173, v254, v255
    v_lshlrev_b32 v252, 16, v174
    v_and_b32 v253, 0xffff0000, v174
    v_pk_mul_f32 v[252:253], v[252:253], s[46:47]
    v_cvt_pk_bf16_f32 v174, v252, v253
    v_lshlrev_b32 v254, 16, v175
    v_and_b32 v255, 0xffff0000, v175
    v_pk_mul_f32 v[254:255], v[254:255], s[46:47]
    v_cvt_pk_bf16_f32 v175, v254, v255
    s_waitcnt lgkmcnt(0)
    v_readfirstlane_b32 s34, v248
    s_nop 0
    s_cmp_ge_u32 s34, s37
    s_cbranch_scc1 L_ok_k0
    s_call_b64 s[38:39], L_poll
L_ok_k0:
    ds_read_b128 v[192:195], v245 offset:2048
    ds_read_b128 v[196:199], v245 offset:3072
    ds_read_b64_tr_b16 v[208:209], v250 offset:0
    ds_read_b64_tr_b16 v[210:211], v250 offset:256
    ds_read_b64_tr_b16 v[212:213], v250 offset:1024
    ds_read_b64_tr_b16 v[214:215], v250 offset:1280
    s_waitcnt lgkmcnt(4)
    v_mfma_f32_32x32x16_bf16 v[0:15], v[192:195], v[160:163], 0
    v_mfma_f32_32x32x16_bf16 v[0:15], v[196:199], v[164:167], v[0:15]
    v_mfma_f32_32x32x16_bf16 v[16:31], v[192:195], v[168:171], 0
    v_mfma_f32_32x32x16_bf16 v[16:31], v[196:199], v[172:175], v[16:31]
    ds_read_b32 v248, v246
    s_mov_b32 s37, 2
    s_nop 7
    v_max3_f32 v252, v0, v1, v2
    v_max3_f32 v253, v3, v4, v5
    v_max3_f32 v254, v6, v7, v8
    v_max3_f32 v255, v9, v10, v11
    v_max3_f32 v252, v252, v12, v13
    v_max3_f32 v253, v253, v14, v15
    v_max3_f32 v252, v252, v16, v17
    v_max3_f32 v253, v253, v18, v19
    v_max3_f32 v254, v254, v20, v21
    v_max3_f32 v255, v255, v22, v23
    v_max3_f32 v252, v252, v24, v25
    v_max3_f32 v253, v253, v26, v27
    v_max3_f32 v254, v254, v28, v29
    v_max3_f32 v255, v255, v30, v31
    v_max3_f32 v252, v252, v254, v255
    v_max_f32 v252, v252, v253
    v_mov_b32 v253, v252
    s_nop 1
    v_permlane32_swap_b32 v252, v253
    s_nop 1
    v_max_f32 v252, v252, v253
    v_add_f32 v252, 0xc2400000, v252
    v_sub_f32 v64, 0, v252
    v_sub_f32 v65, 0, v252
    v_pk_mov_b32 v[66:67], v[64:65], v[64:65]
    v_pk_mov_b32 v[68:69], v[64:65], v[64:65]
    v_pk_mov_b32 v[70:71], v[64:65], v[64:65]
    v_pk_mov_b32 v[72:73], v[64:65], v[64:65]
    v_pk_mov_b32 v[74:75], v[64:65], v[64:65]
    v_pk_mov_b32 v[76:77], v[64:65], v[64:65]
    v_pk_mov_b32 v[78:79], v[64:65], v[64:65]
    s_nop 1
    v_mfma_f32_32x32x16_bf16 v[0:15], v[192:195], v[160:163], v[64:79]
    v_mfma_f32_32x32x16_bf16 v[0:15], v[196:199], v[164:167], v[0:15]
    s_waitcnt lgkmcnt(0)
    v_readfirstlane_b32 s34, v248
    s_nop 0
    s_cmp_ge_u32 s34, s37
    s_cbranch_scc1 L_ok_k1
    s_call_b64 s[38:39], L_poll
L_ok_k1:
    ds_read_b128 v[200:203], v245 offset:4096
    ds_read_b128 v[204:207], v245 offset:5120
    ds_read_b32 v248, v246
    s_nop 7
    s_nop 1
    v_mfma_f32_32x32x16_bf16 v[16:31], v[192:195], v[168:171], v[64:79]
    v_exp_f32 v0, v0
    v_exp_f32 v1, v1
    v_exp_f32 v2, v2
    v_mfma_f32_32x32x16_bf16 v[16:31], v[196:199], v[172:175], v[16:31]
    v_exp_f32 v3, v3
    v_exp_f32 v4, v4
    v_exp_f32 v5, v5
    s_waitcnt lgkmcnt(0)
    v_exp_f32 v6, v6
    v_exp_f32 v7, v7
    v_exp_f32 v8, v8
    ds_read_b64_tr_b16 v[216:217], v250 offset:2048
    ds_read_b64_tr_b16 v[218:219], v250 offset:2304
    v_exp_f32 v9, v9
    v_exp_f32 v10, v10
    v_smfmac_f32_32x32x32_bf16 v[96:111], v[208:211], v[0:7], v244
    s_mov_b32 s37, 3
    v_readfirstlane_b32 s34, v248
    s_nop 0
    s_cmp_ge_u32 s34, s37
    s_cbranch_scc1 L_ok_head0
    s_call_b64 s[38:39], L_poll
L_ok_head0:
    v_exp_f32 v11, v11
    v_exp_f32 v12, v12
    v_exp_f32 v13, v13
    v_smfmac_f32_16x16x64_bf16 v[224:227], v[240:243], v[0:7], v244
    ds_read_b64_tr_b16 v[220:221], v250 offset:3072
    ds_read_b64_tr_b16 v[222:223], v250 offset:3328
    v_exp_f32 v14, v14
    v_exp_f32 v15, v15
    v_mfma_f32_32x32x16_bf16 v[32:47], v[200:203], v[160:163], v[64:79]
    v_exp_f32 v16, v16
    v_exp_f32 v17, v17
    v_exp_f32 v18, v18
    v_mfma_f32_32x32x16_bf16 v[32:47], v[204:207], v[164:167], v[32:47]
    v_exp_f32 v19, v19
    v_exp_f32 v20, v20
    v_exp_f32 v21, v21
    v_smfmac_f32_32x32x32_bf16 v[96:111], v[212:215], v[8:15], v244
    v_exp_f32 v22, v22
    v_exp_f32 v23, v23
    v_exp_f32 v24, v24
    v_smfmac_f32_16x16x64_bf16 v[224:227], v[240:243], v[8:15], v244
    ds_read_b128 v[192:195], v245 offset:6144
    v_exp_f32 v25, v25
    v_exp_f32 v26, v26
    v_smfmac_f32_32x32x32_bf16 v[112:127], v[208:211], v[16:23], v244
    ds_read_b32 v248, v246
    v_exp_f32 v27, v27
    v_exp_f32 v28, v28
    v_exp_f32 v29, v29
    v_smfmac_f32_16x16x64_bf16 v[228:231], v[240:243], v[16:23], v244
    ds_read_b128 v[196:199], v245 offset:7168
    v_exp_f32 v30, v30
    v_exp_f32 v31, v31
    v_mfma_f32_32x32x16_bf16 v[48:63], v[200:203], v[168:171], v[64:79]
    v_exp_f32 v32, v32
    v_exp_f32 v33, v33
    v_exp_f32 v34, v34
    v_mfma_f32_32x32x16_bf16 v[48:63], v[204:207], v[172:175], v[48:63]
    v_exp_f32 v35, v35
    v_exp_f32 v36, v36
    v_exp_f32 v37, v37
    v_smfmac_f32_32x32x32_bf16 v[112:127], v[212:215], v[24:31], v244
    s_waitcnt lgkmcnt(0)
    v_exp_f32 v38, v38
    v_exp_f32 v39, v39
    v_exp_f32 v40, v40
    v_smfmac_f32_16x16x64_bf16 v[228:231], v[240:243], v[24:31], v244
    ds_read_b64_tr_b16 v[208:209], v250 offset:4096
    ds_read_b64_tr_b16 v[210:211], v250 offset:4352
    v_exp_f32 v41, v41
    v_exp_f32 v42, v42
    v_smfmac_f32_32x32x32_bf16 v[96:111], v[216:219], v[32:39], v244
    s_mov_b32 s37, 4
    v_readfirstlane_b32 s34, v248
    s_nop 0
    s_cmp_ge_u32 s34, s37
    s_cbranch_scc1 L_ok_head1
    s_call_b64 s[38:39], L_poll
L_ok_head1:
    v_exp_f32 v43, v43
    v_exp_f32 v44, v44
    v_exp_f32 v45, v45
    v_smfmac_f32_16x16x64_bf16 v[224:227], v[240:243], v[32:39], v244
    ds_read_b64_tr_b16 v[212:213], v250 offset:5120
    ds_read_b64_tr_b16 v[214:215], v250 offset:5376
    v_exp_f32 v46, v46
    v_exp_f32 v47, v47
    v_mfma_f32_32x32x16_bf16 v[0:15], v[192:195], v[160:163], v[64:79]
    v_exp_f32 v48, v48
    v_exp_f32 v49, v49
    v_exp_f32 v50, v50
    v_mfma_f32_32x32x16_bf16 v[0:15], v[196:199], v[164:167], v[0:15]
    v_exp_f32 v51, v51
    v_exp_f32 v52, v52
    v_exp_f32 v53, v53
    v_smfmac_f32_32x32x32_bf16 v[96:111], v[220:223], v[40:47], v244
    v_exp_f32 v54, v54
    v_exp_f32 v55, v55
    v_exp_f32 v56, v56
    v_smfmac_f32_16x16x64_bf16 v[224:227], v[240:243], v[40:47], v244
    ds_read_b128 v[200:203], v245 offset:8192
    v_exp_f32 v57, v57
    v_exp_f32 v58, v58
    v_smfmac_f32_32x32x32_bf16 v[112:127], v[216:219], v[48:55], v244
    ds_read_b32 v248, v246
    v_exp_f32 v59, v59
    v_exp_f32 v60, v60
    v_exp_f32 v61, v61
    v_smfmac_f32_16x16x64_bf16 v[228:231], v[240:243], v[48:55], v244
    ds_read_b128 v[204:207], v245 offset:9216
    v_exp_f32 v62, v62
    v_exp_f32 v63, v63
    s_waitcnt vmcnt(0)
    v_lshlrev_b32 v252, 16, v176
    v_and_b32 v253, 0xffff0000, v176
    v_pk_mul_f32 v[252:253], v[252:253], s[46:47]
    v_cvt_pk_bf16_f32 v176, v252, v253
    v_lshlrev_b32 v254, 16, v177
    v_and_b32 v255, 0xffff0000, v177
    v_pk_mul_f32 v[254:255], v[254:255], s[46:47]
    v_cvt_pk_bf16_f32 v177, v254, v255
    v_lshlrev_b32 v252, 16, v178
    v_and_b32 v253, 0xffff0000, v178
    v_pk_mul_f32 v[252:253], v[252:253], s[46:47]
    v_cvt_pk_bf16_f32 v178, v252, v253
    v_lshlrev_b32 v254, 16, v179
    v_and_b32 v255, 0xffff0000, v179
    v_pk_mul_f32 v[254:255], v[254:255], s[46:47]
    v_cvt_pk_bf16_f32 v179, v254, v255
    v_lshlrev_b32 v252, 16, v180
    v_and_b32 v253, 0xffff0000, v180
    v_pk_mul_f32 v[252:253], v[252:253], s[46:47]
    v_cvt_pk_bf16_f32 v180, v252, v253
    v_lshlrev_b32 v254, 16, v181
    v_and_b32 v255, 0xffff0000, v181
    v_pk_mul_f32 v[254:255], v[254:255], s[46:47]
    v_cvt_pk_bf16_f32 v181, v254, v255
    v_lshlrev_b32 v252, 16, v182
    v_and_b32 v253, 0xffff0000, v182
    v_pk_mul_f32 v[252:253], v[252:253], s[46:47]
    v_cvt_pk_bf16_f32 v182, v252, v253
    v_lshlrev_b32 v254, 16, v183
    v_and_b32 v255, 0xffff0000, v183
    v_pk_mul_f32 v[254:255], v[254:255], s[46:47]
    v_cvt_pk_bf16_f32 v183, v254, v255
    v_lshlrev_b32 v252, 16, v184
    v_and_b32 v253, 0xffff0000, v184
    v_pk_mul_f32 v[252:253], v[252:253], s[46:47]
    v_cvt_pk_bf16_f32 v184, v252, v253
    v_lshlrev_b32 v254, 16, v185
    v_and_b32 v255, 0xffff0000, v185
    v_pk_mul_f32 v[254:255], v[254:255], s[46:47]
    v_cvt_pk_bf16_f32 v185, v254, v255
    v_lshlrev_b32 v252, 16, v186
    v_and_b32 v253, 0xffff0000, v186
    v_pk_mul_f32 v[252:253], v[252:253], s[46:47]
    v_cvt_pk_bf16_f32 v186, v252, v253
    v_lshlrev_b32 v254, 16, v187
    v_and_b32 v255, 0xffff0000, v187
    v_pk_mul_f32 v[254:255], v[254:255], s[46:47]
    v_cvt_pk_bf16_f32 v187, v254, v255
    v_lshlrev_b32 v252, 16, v188
    v_and_b32 v253, 0xffff0000, v188
    v_pk_mul_f32 v[252:253], v[252:253], s[46:47]
    v_cvt_pk_bf16_f32 v188, v252, v253
    v_lshlrev_b32 v254, 16, v189
    v_and_b32 v255, 0xffff0000, v189
    v_pk_mul_f32 v[254:255], v[254:255], s[46:47]
    v_cvt_pk_bf16_f32 v189, v254, v255
    v_lshlrev_b32 v252, 16, v190
    v_and_b32 v253, 0xffff0000, v190
    v_pk_mul_f32 v[252:253], v[252:253], s[46:47]
    v_cvt_pk_bf16_f32 v190, v252, v253
    v_lshlrev_b32 v254, 16, v191
    v_and_b32 v255, 0xffff0000, v191
    v_pk_mul_f32 v[254:255], v[254:255], s[46:47]
    v_cvt_pk_bf16_f32 v191, v254, v255
    s_nop 1
    v_mfma_f32_32x32x16_bf16 v[16:31], v[192:195], v[176:179], 0
    v_mfma_f32_32x32x16_bf16 v[16:31], v[196:199], v[180:183], v[16:31]
    v_mfma_f32_32x32x16_bf16 v[32:47], v[192:195], v[184:187], 0
    v_mfma_f32_32x32x16_bf16 v[32:47], v[196:199], v[188:191], v[32:47]
    s_nop 7
    s_nop 1
    v_max3_f32 v252, v16, v17, v18
    v_max3_f32 v253, v19, v20, v21
    v_max3_f32 v254, v22, v23, v24
    v_max3_f32 v255, v25, v26, v27
    v_max3_f32 v252, v252, v28, v29
    v_max3_f32 v253, v253, v30, v31
    v_max3_f32 v252, v252, v32, v33
    v_max3_f32 v253, v253, v34, v35
    v_max3_f32 v254, v254, v36, v37
    v_max3_f32 v255, v255, v38, v39
    v_max3_f32 v252, v252, v40, v41
    v_max3_f32 v253, v253, v42, v43
    v_max3_f32 v254, v254, v44, v45
    v_max3_f32 v255, v255, v46, v47
    v_max3_f32 v252, v252, v254, v255
    v_max_f32 v252, v252, v253
    v_mov_b32 v253, v252
    s_nop 1
    v_permlane32_swap_b32 v252, v253
    s_nop 1
    v_max_f32 v252, v252, v253
    v_add_f32 v252, 0xc2400000, v252
    v_sub_f32 v80, 0, v252
    v_sub_f32 v81, 0, v252
    v_pk_mov_b32 v[82:83], v[80:81], v[80:81]
    v_pk_mov_b32 v[84:85], v[80:81], v[80:81]
    v_pk_mov_b32 v[86:87], v[80:81], v[80:81]
    v_pk_mov_b32 v[88:89], v[80:81], v[80:81]
    v_pk_mov_b32 v[90:91], v[80:81], v[80:81]
    v_pk_mov_b32 v[92:93], v[80:81], v[80:81]
    v_pk_mov_b32 v[94:95], v[80:81], v[80:81]
    s_nop 1
    v_mfma_f32_32x32x16_bf16 v[16:31], v[192:195], v[168:171], v[64:79]
    v_exp_f32 v0, v0
    v_exp_f32 v1, v1
    v_exp_f32 v2, v2
    v_mfma_f32_32x32x16_bf16 v[16:31], v[196:199], v[172:175], v[16:31]
    v_exp_f32 v3, v3
    v_exp_f32 v4, v4
    v_exp_f32 v5, v5
    v_smfmac_f32_32x32x32_bf16 v[112:127], v[220:223], v[56:63], v244
    s_waitcnt lgkmcnt(0)
    v_exp_f32 v6, v6
    v_exp_f32 v7, v7
    v_exp_f32 v8, v8
    v_smfmac_f32_16x16x64_bf16 v[228:231], v[240:243], v[56:63], v244
    ds_read_b64_tr_b16 v[216:217], v250 offset:6144
    ds_read_b64_tr_b16 v[218:219], v250 offset:6400
    v_exp_f32 v9, v9
    v_exp_f32 v10, v10
    v_smfmac_f32_32x32x32_bf16 v[96:111], v[208:211], v[0:7], v244
    s_mov_b32 s37, 5
    v_readfirstlane_b32 s34, v248
    s_mov_b32 s32, 16384
    s_cmp_ge_u32 s34, s37
    s_cbranch_scc1 L_ok_head2
    s_call_b64 s[38:39], L_poll
L_ok_head2:
    v_exp_f32 v11, v11
    v_exp_f32 v12, v12
    v_exp_f32 v13, v13
    v_smfmac_f32_16x16x64_bf16 v[224:227], v[240:243], v[0:7], v244
    ds_read_b64_tr_b16 v[220:221], v250 offset:7168
    ds_read_b64_tr_b16 v[222:223], v250 offset:7424
    v_exp_f32 v14, v14
    v_exp_f32 v15, v15
    v_mfma_f32_32x32x16_bf16 v[32:47], v[200:203], v[160:163], v[64:79]
    v_exp_f32 v16, v16
    v_exp_f32 v17, v17
    v_exp_f32 v18, v18
    v_mfma_f32_32x32x16_bf16 v[32:47], v[204:207], v[164:167], v[32:47]
    v_add_u32 v245, s32, v246
    v_exp_f32 v19, v19
    v_exp_f32 v20, v20
    v_exp_f32 v21, v21
    v_smfmac_f32_32x32x32_bf16 v[96:111], v[212:215], v[8:15], v244
    v_exp_f32 v22, v22
    v_exp_f32 v23, v23
    v_exp_f32 v24, v24
    v_smfmac_f32_16x16x64_bf16 v[224:227], v[240:243], v[8:15], v244
    ds_read_b128 v[192:195], v245 offset:2048
    v_exp_f32 v25, v25
    v_exp_f32 v26, v26
    v_smfmac_f32_32x32x32_bf16 v[112:127], v[208:211], v[16:23], v244
    ds_read_b32 v248, v246
    v_exp_f32 v27, v27
    v_exp_f32 v28, v28
    v_exp_f32 v29, v29
    v_smfmac_f32_16x16x64_bf16 v[228:231], v[240:243], v[16:23], v244
    ds_read_b128 v[196:199], v245 offset:3072
    v_exp_f32 v30, v30
    v_exp_f32 v31, v31
    v_mfma_f32_32x32x16_bf16 v[48:63], v[200:203], v[168:171], v[64:79]
    v_exp_f32 v32, v32
    v_exp_f32 v33, v33
    v_exp_f32 v34, v34
    v_mfma_f32_32x32x16_bf16 v[48:63], v[204:207], v[172:175], v[48:63]
    v_add_u32 v250, s32, v251
    v_exp_f32 v35, v35
    v_exp_f32 v36, v36
    v_exp_f32 v37, v37
    v_smfmac_f32_32x32x32_bf16 v[112:127], v[212:215], v[24:31], v244
    s_waitcnt lgkmcnt(0)
    v_exp_f32 v38, v38
    v_exp_f32 v39, v39
    v_exp_f32 v40, v40
    v_smfmac_f32_16x16x64_bf16 v[228:231], v[240:243], v[24:31], v244
    ds_read_b64_tr_b16 v[208:209], v250 offset:0
    ds_read_b64_tr_b16 v[210:211], v250 offset:256
    v_exp_f32 v41, v41
    v_exp_f32 v42, v42
    v_smfmac_f32_32x32x32_bf16 v[96:111], v[216:219], v[32:39], v244
    s_mov_b32 s37, 8
    v_readfirstlane_b32 s34, v248
    s_nop 0
    s_cmp_ge_u32 s34, s37
    s_cbranch_scc1 L_ok_head3
    s_call_b64 s[38:39], L_poll
L_ok_head3:
    v_exp_f32 v43, v43
    v_exp_f32 v44, v44
    v_exp_f32 v45, v45
    v_smfmac_f32_16x16x64_bf16 v[224:227], v[240:243], v[32:39], v244
    ds_read_b64_tr_b16 v[212:213], v250 offset:1024
    ds_read_b64_tr_b16 v[214:215], v250 offset:1280
    v_exp_f32 v46, v46
    v_exp_f32 v47, v47
    v_mfma_f32_32x32x16_bf16 v[0:15], v[192:195], v[176:179], v[80:95]
    v_exp_f32 v48, v48
    v_exp_f32 v49, v49
    v_exp_f32 v50, v50
    v_mfma_f32_32x32x16_bf16 v[0:15], v[196:199], v[180:183], v[0:15]
    v_exp_f32 v51, v51
    v_exp_f32 v52, v52
    v_exp_f32 v53, v53
    v_smfmac_f32_32x32x32_bf16 v[96:111], v[220:223], v[40:47], v244
    v_exp_f32 v54, v54
    v_exp_f32 v55, v55
    v_exp_f32 v56, v56
    v_smfmac_f32_16x16x64_bf16 v[224:227], v[240:243], v[40:47], v244
    ds_read_b128 v[200:203], v245 offset:4096
    v_exp_f32 v57, v57
    v_exp_f32 v58, v58
    v_smfmac_f32_32x32x32_bf16 v[112:127], v[216:219], v[48:55], v244
    ds_add_u32 v247, v244
    s_mov_b32 s33, 1
    v_exp_f32 v59, v59
    v_exp_f32 v60, v60
    v_exp_f32 v61, v61
    v_smfmac_f32_16x16x64_bf16 v[228:231], v[240:243], v[48:55], v244
    ds_read_b128 v[204:207], v245 offset:5120
.p2align 6
L_loop:
    v_exp_f32 v62, v62
    v_exp_f32 v63, v63
    v_mfma_f32_32x32x16_bf16 v[16:31], v[192:195], v[184:187], v[80:95]
    v_exp_f32 v0, v0
    v_exp_f32 v1, v1
    v_exp_f32 v2, v2
    v_mfma_f32_32x32x16_bf16 v[16:31], v[196:199], v[188:191], v[16:31]
    v_exp_f32 v3, v3
    v_exp_f32 v4, v4
    v_exp_f32 v5, v5
    v_smfmac_f32_32x32x32_bf16 v[112:127], v[220:223], v[56:63], v244
    s_waitcnt lgkmcnt(0)
    v_exp_f32 v6, v6
    v_exp_f32 v7, v7
    v_exp_f32 v8, v8
    v_smfmac_f32_16x16x64_bf16 v[228:231], v[240:243], v[56:63], v244
    ds_read_b64_tr_b16 v[216:217], v250 offset:2048
    v_exp_f32 v9, v9
    v_exp_f32 v10, v10
    v_smfmac_f32_32x32x32_bf16 v[128:143], v[208:211], v[0:7], v244
    v_exp_f32 v11, v11
    v_exp_f32 v12, v12
    v_exp_f32 v13, v13
    v_smfmac_f32_16x16x64_bf16 v[232:235], v[240:243], v[0:7], v244
    ds_read_b64_tr_b16 v[218:219], v250 offset:2304
    v_exp_f32 v14, v14
    v_exp_f32 v15, v15
    v_mfma_f32_32x32x16_bf16 v[32:47], v[192:195], v[160:163], v[64:79]
    v_exp_f32 v16, v16
    v_exp_f32 v17, v17
    v_exp_f32 v18, v18
    v_mfma_f32_32x32x16_bf16 v[32:47], v[196:199], v[164:167], v[32:47]
    v_exp_f32 v19, v19
    v_exp_f32 v20, v20
    v_exp_f32 v21, v21
    v_smfmac_f32_32x32x32_bf16 v[128:143], v[212:215], v[8:15], v244
    v_exp_f32 v22, v22
    v_exp_f32 v23, v23
    v_exp_f32 v24, v24
    v_smfmac_f32_16x16x64_bf16 v[232:235], v[240:243], v[8:15], v244
    ds_read_b64_tr_b16 v[220:221], v250 offset:3072
    v_exp_f32 v25, v25
    v_exp_f32 v26, v26
    v_smfmac_f32_32x32x32_bf16 v[144:159], v[208:211], v[16:23], v244
    v_exp_f32 v27, v27
    v_exp_f32 v28, v28
    v_exp_f32 v29, v29
    v_smfmac_f32_16x16x64_bf16 v[236:239], v[240:243], v[16:23], v244
    ds_read_b64_tr_b16 v[222:223], v250 offset:3328
    v_exp_f32 v30, v30
    v_exp_f32 v31, v31
    v_mfma_f32_32x32x16_bf16 v[48:63], v[192:195], v[168:171], v[64:79]
    v_exp_f32 v32, v32
    v_exp_f32 v33, v33
    v_exp_f32 v34, v34
    v_mfma_f32_32x32x16_bf16 v[48:63], v[196:199], v[172:175], v[48:63]
    v_exp_f32 v35, v35
    v_exp_f32 v36, v36
    v_exp_f32 v37, v37
    v_smfmac_f32_32x32x32_bf16 v[144:159], v[212:215], v[24:31], v244
    v_exp_f32 v38, v38
    v_exp_f32 v39, v39
    v_exp_f32 v40, v40
    v_smfmac_f32_16x16x64_bf16 v[236:239], v[240:243], v[24:31], v244
    ds_read_b128 v[192:195], v245 offset:6144
    v_exp_f32 v41, v41
    v_exp_f32 v42, v42
    v_smfmac_f32_32x32x32_bf16 v[96:111], v[208:211], v[32:39], v244
    v_exp_f32 v43, v43
    v_exp_f32 v44, v44
    v_exp_f32 v45, v45
    v_smfmac_f32_16x16x64_bf16 v[224:227], v[240:243], v[32:39], v244
    ds_read_b128 v[196:199], v245 offset:7168
    v_exp_f32 v46, v46
    v_exp_f32 v47, v47
    v_mfma_f32_32x32x16_bf16 v[0:15], v[200:203], v[176:179], v[80:95]
    v_exp_f32 v48, v48
    v_exp_f32 v49, v49
    v_exp_f32 v50, v50
    v_mfma_f32_32x32x16_bf16 v[0:15], v[204:207], v[180:183], v[0:15]
    v_exp_f32 v51, v51
    v_exp_f32 v52, v52
    v_exp_f32 v53, v53
    v_smfmac_f32_32x32x32_bf16 v[96:111], v[212:215], v[40:47], v244
    v_exp_f32 v54, v54
    v_exp_f32 v55, v55
    v_exp_f32 v56, v56
    v_smfmac_f32_16x16x64_bf16 v[224:227], v[240:243], v[40:47], v244
    v_exp_f32 v57, v57
    v_exp_f32 v58, v58
    v_smfmac_f32_32x32x32_bf16 v[112:127], v[208:211], v[48:55], v244
    v_exp_f32 v59, v59
    v_exp_f32 v60, v60
    v_exp_f32 v61, v61
    v_smfmac_f32_16x16x64_bf16 v[228:231], v[240:243], v[48:55], v244
    v_exp_f32 v62, v62
    v_exp_f32 v63, v63
    v_mfma_f32_32x32x16_bf16 v[16:31], v[200:203], v[184:187], v[80:95]
    v_exp_f32 v0, v0
    v_exp_f32 v1, v1
    v_exp_f32 v2, v2
    v_mfma_f32_32x32x16_bf16 v[16:31], v[204:207], v[188:191], v[16:31]
    v_exp_f32 v3, v3
    v_exp_f32 v4, v4
    v_exp_f32 v5, v5
    v_smfmac_f32_32x32x32_bf16 v[112:127], v[212:215], v[56:63], v244
    s_waitcnt lgkmcnt(0)
    v_exp_f32 v6, v6
    v_exp_f32 v7, v7
    v_exp_f32 v8, v8
    v_smfmac_f32_16x16x64_bf16 v[228:231], v[240:243], v[56:63], v244
    ds_read_b64_tr_b16 v[208:209], v250 offset:4096
    v_exp_f32 v9, v9
    v_exp_f32 v10, v10
    v_smfmac_f32_32x32x32_bf16 v[128:143], v[216:219], v[0:7], v244
    v_exp_f32 v11, v11
    v_exp_f32 v12, v12
    v_exp_f32 v13, v13
    v_smfmac_f32_16x16x64_bf16 v[232:235], v[240:243], v[0:7], v244
    ds_read_b64_tr_b16 v[210:211], v250 offset:4352
    v_exp_f32 v14, v14
    v_exp_f32 v15, v15
    v_mfma_f32_32x32x16_bf16 v[32:47], v[200:203], v[160:163], v[64:79]
    v_exp_f32 v16, v16
    v_exp_f32 v17, v17
    v_exp_f32 v18, v18
    v_mfma_f32_32x32x16_bf16 v[32:47], v[204:207], v[164:167], v[32:47]
    v_exp_f32 v19, v19
    v_exp_f32 v20, v20
    v_exp_f32 v21, v21
    v_smfmac_f32_32x32x32_bf16 v[128:143], v[220:223], v[8:15], v244
    v_exp_f32 v22, v22
    v_exp_f32 v23, v23
    v_exp_f32 v24, v24
    v_smfmac_f32_16x16x64_bf16 v[232:235], v[240:243], v[8:15], v244
    ds_read_b64_tr_b16 v[212:213], v250 offset:5120
    v_exp_f32 v25, v25
    v_exp_f32 v26, v26
    v_smfmac_f32_32x32x32_bf16 v[144:159], v[216:219], v[16:23], v244
    v_exp_f32 v27, v27
    v_exp_f32 v28, v28
    v_exp_f32 v29, v29
    v_smfmac_f32_16x16x64_bf16 v[236:239], v[240:243], v[16:23], v244
    ds_read_b64_tr_b16 v[214:215], v250 offset:5376
    v_exp_f32 v30, v30
    v_exp_f32 v31, v31
    v_mfma_f32_32x32x16_bf16 v[48:63], v[200:203], v[168:171], v[64:79]
    v_exp_f32 v32, v32
    v_exp_f32 v33, v33
    v_exp_f32 v34, v34
    v_mfma_f32_32x32x16_bf16 v[48:63], v[204:207], v[172:175], v[48:63]
    v_exp_f32 v35, v35
    v_exp_f32 v36, v36
    v_exp_f32 v37, v37
    v_smfmac_f32_32x32x32_bf16 v[144:159], v[220:223], v[24:31], v244
    v_exp_f32 v38, v38
    v_exp_f32 v39, v39
    v_exp_f32 v40, v40
    v_smfmac_f32_16x16x64_bf16 v[236:239], v[240:243], v[24:31], v244
    ds_read_b128 v[200:203], v245 offset:8192
    v_exp_f32 v41, v41
    v_exp_f32 v42, v42
    v_smfmac_f32_32x32x32_bf16 v[96:111], v[216:219], v[32:39], v244
    v_exp_f32 v43, v43
    v_exp_f32 v44, v44
    v_exp_f32 v45, v45
    v_smfmac_f32_16x16x64_bf16 v[224:227], v[240:243], v[32:39], v244
    ds_read_b128 v[204:207], v245 offset:9216
    v_exp_f32 v46, v46
    v_exp_f32 v47, v47
    v_mfma_f32_32x32x16_bf16 v[0:15], v[192:195], v[176:179], v[80:95]
    v_exp_f32 v48, v48
    v_exp_f32 v49, v49
    v_exp_f32 v50, v50
    v_mfma_f32_32x32x16_bf16 v[0:15], v[196:199], v[180:183], v[0:15]
    v_exp_f32 v51, v51
    v_exp_f32 v52, v52
    v_exp_f32 v53, v53
    v_smfmac_f32_32x32x32_bf16 v[96:111], v[220:223], v[40:47], v244
    v_exp_f32 v54, v54
    v_exp_f32 v55, v55
    v_exp_f32 v56, v56
    v_smfmac_f32_16x16x64_bf16 v[224:227], v[240:243], v[40:47], v244
    ds_read_b32 v248, v246
    v_exp_f32 v57, v57
    v_exp_f32 v58, v58
    v_smfmac_f32_32x32x32_bf16 v[112:127], v[216:219], v[48:55], v244
    v_exp_f32 v59, v59
    v_exp_f32 v60, v60
    v_exp_f32 v61, v61
    v_smfmac_f32_16x16x64_bf16 v[228:231], v[240:243], v[48:55], v244
    v_exp_f32 v62, v62
    v_exp_f32 v63, v63
    v_mfma_f32_32x32x16_bf16 v[16:31], v[192:195], v[184:187], v[80:95]
    v_exp_f32 v0, v0
    v_exp_f32 v1, v1
    v_exp_f32 v2, v2
    v_mfma_f32_32x32x16_bf16 v[16:31], v[196:199], v[188:191], v[16:31]
    v_exp_f32 v3, v3
    v_exp_f32 v4, v4
    v_exp_f32 v5, v5
    v_smfmac_f32_32x32x32_bf16 v[112:127], v[220:223], v[56:63], v244
    s_waitcnt lgkmcnt(0)
    v_exp_f32 v6, v6
    v_exp_f32 v7, v7
    v_exp_f32 v8, v8
    v_smfmac_f32_16x16x64_bf16 v[228:231], v[240:243], v[56:63], v244
    ds_read_b64_tr_b16 v[216:217], v250 offset:6144
    v_exp_f32 v9, v9
    v_exp_f32 v10, v10
    v_smfmac_f32_32x32x32_bf16 v[128:143], v[208:211], v[0:7], v244
    v_exp_f32 v11, v11
    v_exp_f32 v12, v12
    v_exp_f32 v13, v13
    v_smfmac_f32_16x16x64_bf16 v[232:235], v[240:243], v[0:7], v244
    ds_read_b64_tr_b16 v[218:219], v250 offset:6400
    v_exp_f32 v14, v14
    v_exp_f32 v15, v15
    v_mfma_f32_32x32x16_bf16 v[32:47], v[192:195], v[160:163], v[64:79]
    s_add_u32 s37, s37, 4
    v_exp_f32 v16, v16
    v_exp_f32 v17, v17
    v_exp_f32 v18, v18
    v_mfma_f32_32x32x16_bf16 v[32:47], v[196:199], v[164:167], v[32:47]
    s_add_u32 s32, s32, 16384
    v_readfirstlane_b32 s34, v248
    v_exp_f32 v19, v19
    v_exp_f32 v20, v20
    v_exp_f32 v21, v21
    v_smfmac_f32_32x32x32_bf16 v[128:143], v[212:215], v[8:15], v244
    s_and_b32 s32, s32, 131071
    v_exp_f32 v22, v22
    v_exp_f32 v23, v23
    v_exp_f32 v24, v24
    v_smfmac_f32_16x16x64_bf16 v[232:235], v[240:243], v[8:15], v244
    ds_read_b64_tr_b16 v[220:221], v250 offset:7168
    v_exp_f32 v25, v25
    v_exp_f32 v26, v26
    v_smfmac_f32_32x32x32_bf16 v[144:159], v[208:211], v[16:23], v244
    s_cmp_ge_u32 s34, s37
    s_cbranch_scc0 L_slow_body0
L_ok_body0:
    v_exp_f32 v27, v27
    v_exp_f32 v28, v28
    v_exp_f32 v29, v29
    v_smfmac_f32_16x16x64_bf16 v[236:239], v[240:243], v[16:23], v244
    ds_read_b64_tr_b16 v[222:223], v250 offset:7424
    v_exp_f32 v30, v30
    v_exp_f32 v31, v31
    v_mfma_f32_32x32x16_bf16 v[48:63], v[192:195], v[168:171], v[64:79]
    v_exp_f32 v32, v32
    v_exp_f32 v33, v33
    v_exp_f32 v34, v34
    v_mfma_f32_32x32x16_bf16 v[48:63], v[196:199], v[172:175], v[48:63]
    v_add_u32 v245, s32, v246
    v_exp_f32 v35, v35
    v_exp_f32 v36, v36
    v_exp_f32 v37, v37
    v_smfmac_f32_32x32x32_bf16 v[144:159], v[212:215], v[24:31], v244
    v_exp_f32 v38, v38
    v_exp_f32 v39, v39
    v_exp_f32 v40, v40
    v_smfmac_f32_16x16x64_bf16 v[236:239], v[240:243], v[24:31], v244
    ds_read_b128 v[192:195], v245 offset:2048
    v_exp_f32 v41, v41
    v_exp_f32 v42, v42
    v_smfmac_f32_32x32x32_bf16 v[96:111], v[208:211], v[32:39], v244
    v_exp_f32 v43, v43
    v_exp_f32 v44, v44
    v_exp_f32 v45, v45
    v_smfmac_f32_16x16x64_bf16 v[224:227], v[240:243], v[32:39], v244
    ds_read_b128 v[196:199], v245 offset:3072
    v_exp_f32 v46, v46
    v_exp_f32 v47, v47
    v_mfma_f32_32x32x16_bf16 v[0:15], v[200:203], v[176:179], v[80:95]
    v_exp_f32 v48, v48
    v_exp_f32 v49, v49
    v_exp_f32 v50, v50
    v_mfma_f32_32x32x16_bf16 v[0:15], v[204:207], v[180:183], v[0:15]
    v_exp_f32 v51, v51
    v_exp_f32 v52, v52
    v_exp_f32 v53, v53
    v_smfmac_f32_32x32x32_bf16 v[96:111], v[212:215], v[40:47], v244
    v_exp_f32 v54, v54
    v_exp_f32 v55, v55
    v_exp_f32 v56, v56
    v_smfmac_f32_16x16x64_bf16 v[224:227], v[240:243], v[40:47], v244
    v_exp_f32 v57, v57
    v_exp_f32 v58, v58
    v_smfmac_f32_32x32x32_bf16 v[112:127], v[208:211], v[48:55], v244
    v_exp_f32 v59, v59
    v_exp_f32 v60, v60
    v_exp_f32 v61, v61
    v_smfmac_f32_16x16x64_bf16 v[228:231], v[240:243], v[48:55], v244
    v_exp_f32 v62, v62
    v_exp_f32 v63, v63
    v_mfma_f32_32x32x16_bf16 v[16:31], v[200:203], v[184:187], v[80:95]
    v_exp_f32 v0, v0
    v_exp_f32 v1, v1
    v_exp_f32 v2, v2
    v_mfma_f32_32x32x16_bf16 v[16:31], v[204:207], v[188:191], v[16:31]
    v_add_u32 v250, s32, v251
    v_exp_f32 v3, v3
    v_exp_f32 v4, v4
    v_exp_f32 v5, v5
    v_smfmac_f32_32x32x32_bf16 v[112:127], v[212:215], v[56:63], v244
    s_waitcnt lgkmcnt(0)
    v_exp_f32 v6, v6
    v_exp_f32 v7, v7
    v_exp_f32 v8, v8
    v_smfmac_f32_16x16x64_bf16 v[228:231], v[240:243], v[56:63], v244
    ds_read_b64_tr_b16 v[208:209], v250 offset:0
    v_exp_f32 v9, v9
    v_exp_f32 v10, v10
    v_smfmac_f32_32x32x32_bf16 v[128:143], v[216:219], v[0:7], v244
    v_exp_f32 v11, v11
    v_exp_f32 v12, v12
    v_exp_f32 v13, v13
    v_smfmac_f32_16x16x64_bf16 v[232:235], v[240:243], v[0:7], v244
    ds_read_b64_tr_b16 v[210:211], v250 offset:256
    v_exp_f32 v14, v14
    v_exp_f32 v15, v15
    v_mfma_f32_32x32x16_bf16 v[32:47], v[200:203], v[160:163], v[64:79]
    v_exp_f32 v16, v16
    v_exp_f32 v17, v17
    v_exp_f32 v18, v18
    v_mfma_f32_32x32x16_bf16 v[32:47], v[204:207], v[164:167], v[32:47]
    v_exp_f32 v19, v19
    v_exp_f32 v20, v20
    v_exp_f32 v21, v21
    v_smfmac_f32_32x32x32_bf16 v[128:143], v[220:223], v[8:15], v244
    v_exp_f32 v22, v22
    v_exp_f32 v23, v23
    v_exp_f32 v24, v24
    v_smfmac_f32_16x16x64_bf16 v[232:235], v[240:243], v[8:15], v244
    ds_read_b64_tr_b16 v[212:213], v250 offset:1024
    v_exp_f32 v25, v25
    v_exp_f32 v26, v26
    v_smfmac_f32_32x32x32_bf16 v[144:159], v[216:219], v[16:23], v244
    v_exp_f32 v27, v27
    v_exp_f32 v28, v28
    v_exp_f32 v29, v29
    v_smfmac_f32_16x16x64_bf16 v[236:239], v[240:243], v[16:23], v244
    ds_read_b64_tr_b16 v[214:215], v250 offset:1280
    v_exp_f32 v30, v30
    v_exp_f32 v31, v31
    v_mfma_f32_32x32x16_bf16 v[48:63], v[200:203], v[168:171], v[64:79]
    v_exp_f32 v32, v32
    v_exp_f32 v33, v33
    v_exp_f32 v34, v34
    v_mfma_f32_32x32x16_bf16 v[48:63], v[204:207], v[172:175], v[48:63]
    v_exp_f32 v35, v35
    v_exp_f32 v36, v36
    v_exp_f32 v37, v37
    v_smfmac_f32_32x32x32_bf16 v[144:159], v[220:223], v[24:31], v244
    v_exp_f32 v38, v38
    v_exp_f32 v39, v39
    v_exp_f32 v40, v40
    v_smfmac_f32_16x16x64_bf16 v[236:239], v[240:243], v[24:31], v244
    ds_read_b128 v[200:203], v245 offset:4096
    v_exp_f32 v41, v41
    v_exp_f32 v42, v42
    v_smfmac_f32_32x32x32_bf16 v[96:111], v[216:219], v[32:39], v244
    v_exp_f32 v43, v43
    v_exp_f32 v44, v44
    v_exp_f32 v45, v45
    v_smfmac_f32_16x16x64_bf16 v[224:227], v[240:243], v[32:39], v244
    ds_read_b128 v[204:207], v245 offset:5120
    v_exp_f32 v46, v46
    v_exp_f32 v47, v47
    v_mfma_f32_32x32x16_bf16 v[0:15], v[192:195], v[176:179], v[80:95]
    v_exp_f32 v48, v48
    v_exp_f32 v49, v49
    v_exp_f32 v50, v50
    v_mfma_f32_32x32x16_bf16 v[0:15], v[196:199], v[180:183], v[0:15]
    v_exp_f32 v51, v51
    v_exp_f32 v52, v52
    v_exp_f32 v53, v53
    v_smfmac_f32_32x32x32_bf16 v[96:111], v[220:223], v[40:47], v244
    v_exp_f32 v54, v54
    v_exp_f32 v55, v55
    v_exp_f32 v56, v56
    v_smfmac_f32_16x16x64_bf16 v[224:227], v[240:243], v[40:47], v244
    ds_add_u32 v247, v244
    v_exp_f32 v57, v57
    v_exp_f32 v58, v58
    v_smfmac_f32_32x32x32_bf16 v[112:127], v[216:219], v[48:55], v244
    s_add_u32 s33, s33, 1
    s_cmp_lt_u32 s33, 16
    v_exp_f32 v59, v59
    v_exp_f32 v60, v60
    v_exp_f32 v61, v61
    v_smfmac_f32_16x16x64_bf16 v[228:231], v[240:243], v[48:55], v244
    s_cbranch_scc1 L_loop
    v_exp_f32 v62, v62
    v_exp_f32 v63, v63
    v_mfma_f32_32x32x16_bf16 v[16:31], v[192:195], v[184:187], v[80:95]
    v_exp_f32 v0, v0
    v_exp_f32 v1, v1
    v_exp_f32 v2, v2
    v_mfma_f32_32x32x16_bf16 v[16:31], v[196:199], v[188:191], v[16:31]
    v_exp_f32 v3, v3
    v_exp_f32 v4, v4
    v_exp_f32 v5, v5
    v_smfmac_f32_32x32x32_bf16 v[112:127], v[220:223], v[56:63], v244
    s_waitcnt lgkmcnt(0)
    v_exp_f32 v6, v6
    v_exp_f32 v7, v7
    v_exp_f32 v8, v8
    v_smfmac_f32_16x16x64_bf16 v[228:231], v[240:243], v[56:63], v244
    ds_read_b64_tr_b16 v[216:217], v250 offset:2048
    ds_read_b64_tr_b16 v[218:219], v250 offset:2304
    v_exp_f32 v9, v9
    v_exp_f32 v10, v10
    v_smfmac_f32_32x32x32_bf16 v[128:143], v[208:211], v[0:7], v244
    v_exp_f32 v11, v11
    v_exp_f32 v12, v12
    v_exp_f32 v13, v13
    v_smfmac_f32_16x16x64_bf16 v[232:235], v[240:243], v[0:7], v244
    ds_read_b64_tr_b16 v[220:221], v250 offset:3072
    ds_read_b64_tr_b16 v[222:223], v250 offset:3328
    v_exp_f32 v14, v14
    v_exp_f32 v15, v15
    v_mfma_f32_32x32x16_bf16 v[32:47], v[200:203], v[176:179], v[80:95]
    v_exp_f32 v16, v16
    v_exp_f32 v17, v17
    v_exp_f32 v18, v18
    v_mfma_f32_32x32x16_bf16 v[32:47], v[204:207], v[180:183], v[32:47]
    v_exp_f32 v19, v19
    v_exp_f32 v20, v20
    v_exp_f32 v21, v21
    v_smfmac_f32_32x32x32_bf16 v[128:143], v[212:215], v[8:15], v244
    v_exp_f32 v22, v22
    v_exp_f32 v23, v23
    v_exp_f32 v24, v24
    v_smfmac_f32_16x16x64_bf16 v[232:235], v[240:243], v[8:15], v244
    ds_read_b128 v[192:195], v245 offset:6144
    v_exp_f32 v25, v25
    v_exp_f32 v26, v26
    v_smfmac_f32_32x32x32_bf16 v[144:159], v[208:211], v[16:23], v244
    v_exp_f32 v27, v27
    v_exp_f32 v28, v28
    v_exp_f32 v29, v29
    v_smfmac_f32_16x16x64_bf16 v[236:239], v[240:243], v[16:23], v244
    ds_read_b128 v[196:199], v245 offset:7168
    v_exp_f32 v30, v30
    v_exp_f32 v31, v31
    v_and_b32 v248, 0xf0, v246
    v_lshlrev_b32 v248, 2, v248
    v_and_b32 v252, 0x100, v246
    v_lshrrev_b32 v252, 3, v252
    v_or_b32 v248, v248, v252
    v_and_b32 v252, 0x200, v246
    v_lshrrev_b32 v252, 5, v252
    v_or_b32 v248, v248, v252
    v_mov_b32 v225, v224
    s_nop 1
    v_permlane32_swap_b32 v224, v225
    s_nop 0
    v_rcp_f32 v252, v224
    v_rcp_f32 v253, v224
    s_nop 0
    v_pk_mul_f32 v[96:97], v[96:97], v[252:253]
    v_pk_mul_f32 v[98:99], v[98:99], v[252:253]
    v_pk_mul_f32 v[100:101], v[100:101], v[252:253]
    v_pk_mul_f32 v[102:103], v[102:103], v[252:253]
    v_pk_mul_f32 v[104:105], v[104:105], v[252:253]
    v_pk_mul_f32 v[106:107], v[106:107], v[252:253]
    v_pk_mul_f32 v[108:109], v[108:109], v[252:253]
    v_pk_mul_f32 v[110:111], v[110:111], v[252:253]
    v_cvt_pk_bf16_f32 v160, v96, v97
    v_cvt_pk_bf16_f32 v161, v98, v99
    v_cvt_pk_bf16_f32 v162, v100, v101
    v_cvt_pk_bf16_f32 v163, v102, v103
    v_cvt_pk_bf16_f32 v164, v104, v105
    v_cvt_pk_bf16_f32 v165, v106, v107
    v_cvt_pk_bf16_f32 v166, v108, v109
    v_cvt_pk_bf16_f32 v167, v110, v111
    s_nop 1
    v_permlane32_swap_b32 v160, v162
    v_permlane32_swap_b32 v161, v163
    v_permlane32_swap_b32 v164, v166
    v_permlane32_swap_b32 v165, v167
    s_nop 1
    v_permlane16_swap_b32 v160, v164
    v_permlane16_swap_b32 v161, v165
    v_permlane16_swap_b32 v162, v166
    v_permlane16_swap_b32 v163, v167
    s_nop 0
    buffer_store_dwordx4 v[160:163], v248, s[24:27], 0 offen offset:0 sc1
    buffer_store_dwordx4 v[164:167], v248, s[24:27], 0 offen offset:1024 sc1
    v_mov_b32 v229, v228
    s_nop 1
    v_permlane32_swap_b32 v228, v229
    s_nop 0
    v_rcp_f32 v254, v228
    v_rcp_f32 v255, v228
    s_nop 0
    v_pk_mul_f32 v[112:113], v[112:113], v[254:255]
    v_pk_mul_f32 v[114:115], v[114:115], v[254:255]
    v_pk_mul_f32 v[116:117], v[116:117], v[254:255]
    v_pk_mul_f32 v[118:119], v[118:119], v[254:255]
    v_pk_mul_f32 v[120:121], v[120:121], v[254:255]
    v_pk_mul_f32 v[122:123], v[122:123], v[254:255]
    v_pk_mul_f32 v[124:125], v[124:125], v[254:255]
    v_pk_mul_f32 v[126:127], v[126:127], v[254:255]
    v_cvt_pk_bf16_f32 v168, v112, v113
    v_cvt_pk_bf16_f32 v169, v114, v115
    v_cvt_pk_bf16_f32 v170, v116, v117
    v_cvt_pk_bf16_f32 v171, v118, v119
    v_cvt_pk_bf16_f32 v172, v120, v121
    v_cvt_pk_bf16_f32 v173, v122, v123
    v_cvt_pk_bf16_f32 v174, v124, v125
    v_cvt_pk_bf16_f32 v175, v126, v127
    s_nop 1
    v_permlane32_swap_b32 v168, v170
    v_permlane32_swap_b32 v169, v171
    v_permlane32_swap_b32 v172, v174
    v_permlane32_swap_b32 v173, v175
    s_nop 1
    v_permlane16_swap_b32 v168, v172
    v_permlane16_swap_b32 v169, v173
    v_permlane16_swap_b32 v170, v174
    v_permlane16_swap_b32 v171, v175
    s_nop 0
    buffer_store_dwordx4 v[168:171], v248, s[24:27], 0 offen offset:2048 sc1
    buffer_store_dwordx4 v[172:175], v248, s[24:27], 0 offen offset:3072 sc1
    v_maximum3_f32 v64, abs(v96), abs(v97), abs(v97)
    v_maximum3_f32 v65, abs(v98), abs(v99), abs(v99)
    v_maximum3_f32 v66, abs(v100), abs(v101), abs(v101)
    v_maximum3_f32 v67, abs(v102), abs(v103), abs(v103)
    v_maximum3_f32 v64, abs(v104), abs(v105), v64
    v_maximum3_f32 v65, abs(v106), abs(v107), v65
    v_maximum3_f32 v66, abs(v108), abs(v109), v66
    v_maximum3_f32 v67, abs(v110), abs(v111), v67
    v_maximum3_f32 v64, abs(v112), abs(v113), v64
    v_maximum3_f32 v65, abs(v114), abs(v115), v65
    v_maximum3_f32 v66, abs(v116), abs(v117), v66
    v_maximum3_f32 v67, abs(v118), abs(v119), v67
    v_maximum3_f32 v64, abs(v120), abs(v121), v64
    v_maximum3_f32 v65, abs(v122), abs(v123), v65
    v_maximum3_f32 v66, abs(v124), abs(v125), v66
    v_maximum3_f32 v67, abs(v126), abs(v127), v67
    v_maximum3_f32 v64, v64, v65, v66
    v_maximum3_f32 v68, v224, v228, v228
    v_minimum3_f32 v69, v224, v228, v228
    v_maximum3_f32 v64, v64, v67, v67
    v_mov_b32 v65, 0x7b800000
    v_mov_b32 v66, 0x2b800000
    v_mov_b32 v67, 0x7f800000
    v_cmp_nlt_f32 s[38:39], v68, v65
    v_cmp_nlt_f32 vcc, v64, v67
    v_cmp_nge_f32 s[42:43], v69, v66
    s_nop 1
    s_or_b64 vcc, vcc, s[38:39]
    s_or_b64 vcc, vcc, s[42:43]
    s_cmp_lg_u64 vcc, 0
    s_cselect_b32 s34, 1, 0
    s_or_b32 s40, s40, s34
    v_mfma_f32_32x32x16_bf16 v[48:63], v[200:203], v[184:187], v[80:95]
    v_exp_f32 v32, v32
    v_exp_f32 v33, v33
    v_exp_f32 v34, v34
    v_mfma_f32_32x32x16_bf16 v[48:63], v[204:207], v[188:191], v[48:63]
    v_exp_f32 v35, v35
    v_exp_f32 v36, v36
    v_exp_f32 v37, v37
    v_smfmac_f32_32x32x32_bf16 v[144:159], v[212:215], v[24:31], v244
    s_waitcnt lgkmcnt(0)
    v_exp_f32 v38, v38
    v_exp_f32 v39, v39
    v_exp_f32 v40, v40
    v_smfmac_f32_16x16x64_bf16 v[236:239], v[240:243], v[24:31], v244
    ds_read_b64_tr_b16 v[208:209], v250 offset:4096
    ds_read_b64_tr_b16 v[210:211], v250 offset:4352
    v_exp_f32 v41, v41
    v_exp_f32 v42, v42
    v_smfmac_f32_32x32x32_bf16 v[128:143], v[216:219], v[32:39], v244
    v_exp_f32 v43, v43
    v_exp_f32 v44, v44
    v_exp_f32 v45, v45
    v_smfmac_f32_16x16x64_bf16 v[232:235], v[240:243], v[32:39], v244
    ds_read_b64_tr_b16 v[212:213], v250 offset:5120
    ds_read_b64_tr_b16 v[214:215], v250 offset:5376
    v_exp_f32 v46, v46
    v_exp_f32 v47, v47
    v_mfma_f32_32x32x16_bf16 v[0:15], v[192:195], v[176:179], v[80:95]
    v_exp_f32 v48, v48
    v_exp_f32 v49, v49
    v_exp_f32 v50, v50
    v_mfma_f32_32x32x16_bf16 v[0:15], v[196:199], v[180:183], v[0:15]
    v_exp_f32 v51, v51
    v_exp_f32 v52, v52
    v_exp_f32 v53, v53
    v_smfmac_f32_32x32x32_bf16 v[128:143], v[220:223], v[40:47], v244
    v_exp_f32 v54, v54
    v_exp_f32 v55, v55
    v_exp_f32 v56, v56
    v_smfmac_f32_16x16x64_bf16 v[232:235], v[240:243], v[40:47], v244
    ds_read_b128 v[200:203], v245 offset:8192
    v_exp_f32 v57, v57
    v_exp_f32 v58, v58
    v_smfmac_f32_32x32x32_bf16 v[144:159], v[216:219], v[48:55], v244
    v_exp_f32 v59, v59
    v_exp_f32 v60, v60
    v_exp_f32 v61, v61
    v_smfmac_f32_16x16x64_bf16 v[236:239], v[240:243], v[48:55], v244
    ds_read_b128 v[204:207], v245 offset:9216
    v_exp_f32 v62, v62
    v_exp_f32 v63, v63
    v_mfma_f32_32x32x16_bf16 v[16:31], v[192:195], v[184:187], v[80:95]
    v_exp_f32 v0, v0
    v_exp_f32 v1, v1
    v_exp_f32 v2, v2
    v_mfma_f32_32x32x16_bf16 v[16:31], v[196:199], v[188:191], v[16:31]
    v_exp_f32 v3, v3
    v_exp_f32 v4, v4
    v_exp_f32 v5, v5
    v_smfmac_f32_32x32x32_bf16 v[144:159], v[220:223], v[56:63], v244
    s_waitcnt lgkmcnt(0)
    v_exp_f32 v6, v6
    v_exp_f32 v7, v7
    v_exp_f32 v8, v8
    v_smfmac_f32_16x16x64_bf16 v[236:239], v[240:243], v[56:63], v244
    ds_read_b64_tr_b16 v[216:217], v250 offset:6144
    ds_read_b64_tr_b16 v[218:219], v250 offset:6400
    v_exp_f32 v9, v9
    v_exp_f32 v10, v10
    v_smfmac_f32_32x32x32_bf16 v[128:143], v[208:211], v[0:7], v244
    v_exp_f32 v11, v11
    v_exp_f32 v12, v12
    v_exp_f32 v13, v13
    v_smfmac_f32_16x16x64_bf16 v[232:235], v[240:243], v[0:7], v244
    ds_read_b64_tr_b16 v[220:221], v250 offset:7168
    ds_read_b64_tr_b16 v[222:223], v250 offset:7424
    v_exp_f32 v14, v14
    v_exp_f32 v15, v15
    v_mfma_f32_32x32x16_bf16 v[32:47], v[200:203], v[176:179], v[80:95]
    v_exp_f32 v16, v16
    v_exp_f32 v17, v17
    v_exp_f32 v18, v18
    v_mfma_f32_32x32x16_bf16 v[32:47], v[204:207], v[180:183], v[32:47]
    v_exp_f32 v19, v19
    v_exp_f32 v20, v20
    v_exp_f32 v21, v21
    v_smfmac_f32_32x32x32_bf16 v[128:143], v[212:215], v[8:15], v244
    v_exp_f32 v22, v22
    v_exp_f32 v23, v23
    v_exp_f32 v24, v24
    v_smfmac_f32_16x16x64_bf16 v[232:235], v[240:243], v[8:15], v244
    v_exp_f32 v25, v25
    v_exp_f32 v26, v26
    v_smfmac_f32_32x32x32_bf16 v[144:159], v[208:211], v[16:23], v244
    v_exp_f32 v27, v27
    v_exp_f32 v28, v28
    v_exp_f32 v29, v29
    v_smfmac_f32_16x16x64_bf16 v[236:239], v[240:243], v[16:23], v244
    v_exp_f32 v30, v30
    v_exp_f32 v31, v31
    v_mfma_f32_32x32x16_bf16 v[48:63], v[200:203], v[184:187], v[80:95]
    v_exp_f32 v32, v32
    v_exp_f32 v33, v33
    v_exp_f32 v34, v34
    v_mfma_f32_32x32x16_bf16 v[48:63], v[204:207], v[188:191], v[48:63]
    v_exp_f32 v35, v35
    v_exp_f32 v36, v36
    v_exp_f32 v37, v37
    v_smfmac_f32_32x32x32_bf16 v[144:159], v[212:215], v[24:31], v244
    s_waitcnt lgkmcnt(0)
    v_exp_f32 v38, v38
    v_exp_f32 v39, v39
    v_exp_f32 v40, v40
    v_smfmac_f32_16x16x64_bf16 v[236:239], v[240:243], v[24:31], v244
    v_exp_f32 v41, v41
    v_exp_f32 v42, v42
    v_smfmac_f32_32x32x32_bf16 v[128:143], v[216:219], v[32:39], v244
    v_exp_f32 v43, v43
    v_exp_f32 v44, v44
    v_exp_f32 v45, v45
    v_smfmac_f32_16x16x64_bf16 v[232:235], v[240:243], v[32:39], v244
    v_exp_f32 v46, v46
    v_exp_f32 v47, v47
    v_exp_f32 v48, v48
    v_exp_f32 v49, v49
    v_exp_f32 v50, v50
    v_exp_f32 v51, v51
    v_exp_f32 v52, v52
    v_exp_f32 v53, v53
    v_smfmac_f32_32x32x32_bf16 v[128:143], v[220:223], v[40:47], v244
    v_exp_f32 v54, v54
    v_exp_f32 v55, v55
    v_exp_f32 v56, v56
    v_smfmac_f32_16x16x64_bf16 v[232:235], v[240:243], v[40:47], v244
    v_exp_f32 v57, v57
    v_exp_f32 v58, v58
    v_smfmac_f32_32x32x32_bf16 v[144:159], v[216:219], v[48:55], v244
    v_exp_f32 v59, v59
    v_exp_f32 v60, v60
    v_exp_f32 v61, v61
    v_smfmac_f32_16x16x64_bf16 v[236:239], v[240:243], v[48:55], v244
    v_exp_f32 v62, v62
    v_exp_f32 v63, v63
    s_nop 1
    v_smfmac_f32_32x32x32_bf16 v[144:159], v[220:223], v[56:63], v244
    v_smfmac_f32_16x16x64_bf16 v[236:239], v[240:243], v[56:63], v244
    v_mov_b32 v233, v232
    s_nop 1
    v_permlane32_swap_b32 v232, v233
    s_nop 0
    v_rcp_f32 v252, v232
    v_rcp_f32 v253, v232
    s_nop 0
    v_pk_mul_f32 v[128:129], v[128:129], v[252:253]
    v_pk_mul_f32 v[130:131], v[130:131], v[252:253]
    v_pk_mul_f32 v[132:133], v[132:133], v[252:253]
    v_pk_mul_f32 v[134:135], v[134:135], v[252:253]
    v_pk_mul_f32 v[136:137], v[136:137], v[252:253]
    v_pk_mul_f32 v[138:139], v[138:139], v[252:253]
    v_pk_mul_f32 v[140:141], v[140:141], v[252:253]
    v_pk_mul_f32 v[142:143], v[142:143], v[252:253]
    v_cvt_pk_bf16_f32 v176, v128, v129
    v_cvt_pk_bf16_f32 v177, v130, v131
    v_cvt_pk_bf16_f32 v178, v132, v133
    v_cvt_pk_bf16_f32 v179, v134, v135
    v_cvt_pk_bf16_f32 v180, v136, v137
    v_cvt_pk_bf16_f32 v181, v138, v139
    v_cvt_pk_bf16_f32 v182, v140, v141
    v_cvt_pk_bf16_f32 v183, v142, v143
    s_nop 1
    v_permlane32_swap_b32 v176, v178
    v_permlane32_swap_b32 v177, v179
    v_permlane32_swap_b32 v180, v182
    v_permlane32_swap_b32 v181, v183
    s_nop 1
    v_permlane16_swap_b32 v176, v180
    v_permlane16_swap_b32 v177, v181
    v_permlane16_swap_b32 v178, v182
    v_permlane16_swap_b32 v179, v183
    s_nop 0
    buffer_store_dwordx4 v[176:179], v248, s[24:27], s41 offen offset:0 sc1
    buffer_store_dwordx4 v[180:183], v248, s[24:27], s41 offen offset:1024 sc1
    v_mov_b32 v237, v236
    s_nop 1
    v_permlane32_swap_b32 v236, v237
    s_nop 0
    v_rcp_f32 v254, v236
    v_rcp_f32 v255, v236
    s_nop 0
    v_pk_mul_f32 v[144:145], v[144:145], v[254:255]
    v_pk_mul_f32 v[146:147], v[146:147], v[254:255]
    v_pk_mul_f32 v[148:149], v[148:149], v[254:255]
    v_pk_mul_f32 v[150:151], v[150:151], v[254:255]
    v_pk_mul_f32 v[152:153], v[152:153], v[254:255]
    v_pk_mul_f32 v[154:155], v[154:155], v[254:255]
    v_pk_mul_f32 v[156:157], v[156:157], v[254:255]
    v_pk_mul_f32 v[158:159], v[158:159], v[254:255]
    v_cvt_pk_bf16_f32 v184, v144, v145
    v_cvt_pk_bf16_f32 v185, v146, v147
    v_cvt_pk_bf16_f32 v186, v148, v149
    v_cvt_pk_bf16_f32 v187, v150, v151
    v_cvt_pk_bf16_f32 v188, v152, v153
    v_cvt_pk_bf16_f32 v189, v154, v155
    v_cvt_pk_bf16_f32 v190, v156, v157
    v_cvt_pk_bf16_f32 v191, v158, v159
    s_nop 1
    v_permlane32_swap_b32 v184, v186
    v_permlane32_swap_b32 v185, v187
    v_permlane32_swap_b32 v188, v190
    v_permlane32_swap_b32 v189, v191
    s_nop 1
    v_permlane16_swap_b32 v184, v188
    v_permlane16_swap_b32 v185, v189
    v_permlane16_swap_b32 v186, v190
    v_permlane16_swap_b32 v187, v191
    s_nop 0
    buffer_store_dwordx4 v[184:187], v248, s[24:27], s41 offen offset:2048 sc1
    buffer_store_dwordx4 v[188:191], v248, s[24:27], s41 offen offset:3072 sc1
    v_maximum3_f32 v64, abs(v128), abs(v129), abs(v129)
    v_maximum3_f32 v65, abs(v130), abs(v131), abs(v131)
    v_maximum3_f32 v66, abs(v132), abs(v133), abs(v133)
    v_maximum3_f32 v67, abs(v134), abs(v135), abs(v135)
    v_maximum3_f32 v64, abs(v136), abs(v137), v64
    v_maximum3_f32 v65, abs(v138), abs(v139), v65
    v_maximum3_f32 v66, abs(v140), abs(v141), v66
    v_maximum3_f32 v67, abs(v142), abs(v143), v67
    v_maximum3_f32 v64, abs(v144), abs(v145), v64
    v_maximum3_f32 v65, abs(v146), abs(v147), v65
    v_maximum3_f32 v66, abs(v148), abs(v149), v66
    v_maximum3_f32 v67, abs(v150), abs(v151), v67
    v_maximum3_f32 v64, abs(v152), abs(v153), v64
    v_maximum3_f32 v65, abs(v154), abs(v155), v65
    v_maximum3_f32 v66, abs(v156), abs(v157), v66
    v_maximum3_f32 v67, abs(v158), abs(v159), v67
    v_maximum3_f32 v64, v64, v65, v66
    v_maximum3_f32 v68, v232, v236, v236
    v_minimum3_f32 v69, v232, v236, v236
    v_maximum3_f32 v64, v64, v67, v67
    v_mov_b32 v65, 0x7b800000
    v_mov_b32 v66, 0x2b800000
    v_mov_b32 v67, 0x7f800000
    v_cmp_nlt_f32 s[38:39], v68, v65
    v_cmp_nlt_f32 vcc, v64, v67
    v_cmp_nge_f32 s[42:43], v69, v66
    s_nop 1
    s_or_b64 vcc, vcc, s[38:39]
    s_or_b64 vcc, vcc, s[42:43]
    s_cmp_lg_u64 vcc, 0
    s_cselect_b32 s34, 2, 0
    s_or_b32 s40, s40, s34
    s_cmp_lg_u32 s40, 0
    s_cbranch_scc1 L_fallback
L_done:
    s_endpgm
L_slow_body0:
    s_sub_u32 s3, s3, 1
    s_cbranch_scc1 L_end
    s_sleep 1
    ds_read_b32 v248, v246
    s_waitcnt lgkmcnt(0)
    v_readfirstlane_b32 s34, v248
    s_nop 0
    s_cmp_ge_u32 s34, s37
    s_cbranch_scc0 L_slow_body0
    s_branch L_ok_body0
L_fallback:
    s_waitcnt vmcnt(0) lgkmcnt(0)
    s_lshl_b32 s32, s28, 11
    s_add_u32 s32, s32, 133120
    s_sub_u32 s34, s32, 10240
    v_add_u32 v250, s34, v251
    s_mov_b32 s41, 0
L_fb_pair:
    s_and_b32 s34, s40, 1
    s_cbranch_scc0 L_fb_next
    buffer_load_dwordx4 v[160:163], v249, s[20:23], s41 offen offset:0
    buffer_load_dwordx4 v[164:167], v249, s[20:23], s41 offen offset:32
    buffer_load_dwordx4 v[168:171], v249, s[20:23], s41 offen offset:2048
    buffer_load_dwordx4 v[172:175], v249, s[20:23], s41 offen offset:2080
    s_waitcnt vmcnt(0)
    v_lshlrev_b32 v252, 16, v160
    v_and_b32 v253, 0xffff0000, v160
    v_pk_mul_f32 v[252:253], v[252:253], s[46:47]
    v_cvt_pk_bf16_f32 v160, v252, v253
    v_lshlrev_b32 v254, 16, v161
    v_and_b32 v255, 0xffff0000, v161
    v_pk_mul_f32 v[254:255], v[254:255], s[46:47]
    v_cvt_pk_bf16_f32 v161, v254, v255
    v_lshlrev_b32 v252, 16, v162
    v_and_b32 v253, 0xffff0000, v162
    v_pk_mul_f32 v[252:253], v[252:253], s[46:47]
    v_cvt_pk_bf16_f32 v162, v252, v253
    v_lshlrev_b32 v254, 16, v163
    v_and_b32 v255, 0xffff0000, v163
    v_pk_mul_f32 v[254:255], v[254:255], s[46:47]
    v_cvt_pk_bf16_f32 v163, v254, v255
    v_lshlrev_b32 v252, 16, v164
    v_and_b32 v253, 0xffff0000, v164
    v_pk_mul_f32 v[252:253], v[252:253], s[46:47]
    v_cvt_pk_bf16_f32 v164, v252, v253
    v_lshlrev_b32 v254, 16, v165
    v_and_b32 v255, 0xffff0000, v165
    v_pk_mul_f32 v[254:255], v[254:255], s[46:47]
    v_cvt_pk_bf16_f32 v165, v254, v255
    v_lshlrev_b32 v252, 16, v166
    v_and_b32 v253, 0xffff0000, v166
    v_pk_mul_f32 v[252:253], v[252:253], s[46:47]
    v_cvt_pk_bf16_f32 v166, v252, v253
    v_lshlrev_b32 v254, 16, v167
    v_and_b32 v255, 0xffff0000, v167
    v_pk_mul_f32 v[254:255], v[254:255], s[46:47]
    v_cvt_pk_bf16_f32 v167, v254, v255
    v_lshlrev_b32 v252, 16, v168
    v_and_b32 v253, 0xffff0000, v168
    v_pk_mul_f32 v[252:253], v[252:253], s[46:47]
    v_cvt_pk_bf16_f32 v168, v252, v253
    v_lshlrev_b32 v254, 16, v169
    v_and_b32 v255, 0xffff0000, v169
    v_pk_mul_f32 v[254:255], v[254:255], s[46:47]
    v_cvt_pk_bf16_f32 v169, v254, v255
    v_lshlrev_b32 v252, 16, v170
    v_and_b32 v253, 0xffff0000, v170
    v_pk_mul_f32 v[252:253], v[252:253], s[46:47]
    v_cvt_pk_bf16_f32 v170, v252, v253
    v_lshlrev_b32 v254, 16, v171
    v_and_b32 v255, 0xffff0000, v171
    v_pk_mul_f32 v[254:255], v[254:255], s[46:47]
    v_cvt_pk_bf16_f32 v171, v254, v255
    v_lshlrev_b32 v252, 16, v172
    v_and_b32 v253, 0xffff0000, v172
    v_pk_mul_f32 v[252:253], v[252:253], s[46:47]
    v_cvt_pk_bf16_f32 v172, v252, v253
    v_lshlrev_b32 v254, 16, v173
    v_and_b32 v255, 0xffff0000, v173
    v_pk_mul_f32 v[254:255], v[254:255], s[46:47]
    v_cvt_pk_bf16_f32 v173, v254, v255
    v_lshlrev_b32 v252, 16, v174
    v_and_b32 v253, 0xffff0000, v174
    v_pk_mul_f32 v[252:253], v[252:253], s[46:47]
    v_cvt_pk_bf16_f32 v174, v252, v253
    v_lshlrev_b32 v254, 16, v175
    v_and_b32 v255, 0xffff0000, v175
    v_pk_mul_f32 v[254:255], v[254:255], s[46:47]
    v_cvt_pk_bf16_f32 v175, v254, v255
    v_mov_b32 v32, 0xff800000
    v_mov_b32 v36, 0xff800000
    s_mov_b32 s31, 0
L_fb_max:
    buffer_load_dwordx4 v[192:195], v249, s[12:15], s31 offen
    buffer_load_dwordx4 v[196:199], v249, s[12:15], s31 offen offset:32
    s_waitcnt vmcnt(0)
    v_mfma_f32_32x32x16_bf16 v[0:15], v[192:195], v[160:163], 0
    v_mfma_f32_32x32x16_bf16 v[0:15], v[196:199], v[164:167], v[0:15]
    v_mfma_f32_32x32x16_bf16 v[16:31], v[192:195], v[168:171], 0
    v_mfma_f32_32x32x16_bf16 v[16:31], v[196:199], v[172:175], v[16:31]
    s_nop 15
    v_max3_f32 v32, v32, v0, v1
    v_max3_f32 v32, v32, v2, v3
    v_max3_f32 v32, v32, v4, v5
    v_max3_f32 v32, v32, v6, v7
    v_max3_f32 v32, v32, v8, v9
    v_max3_f32 v32, v32, v10, v11
    v_max3_f32 v32, v32, v12, v13
    v_max3_f32 v32, v32, v14, v15
    v_max3_f32 v36, v36, v16, v17
    v_max3_f32 v36, v36, v18, v19
    v_max3_f32 v36, v36, v20, v21
    v_max3_f32 v36, v36, v22, v23
    v_max3_f32 v36, v36, v24, v25
    v_max3_f32 v36, v36, v26, v27
    v_max3_f32 v36, v36, v28, v29
    v_max3_f32 v36, v36, v30, v31
    s_add_u32 s31, s31, 2048
    s_cmp_lt_u32 s31, 131072
    s_cbranch_scc1 L_fb_max
    v_mov_b32 v33, v32
    s_nop 1
    v_permlane32_swap_b32 v32, v33
    s_nop 1
    v_max_f32 v32, v32, v33
    v_sub_f32 v64, 0, v32
    v_sub_f32 v65, 0, v32
    v_pk_mov_b32 v[66:67], v[64:65], v[64:65]
    v_pk_mov_b32 v[68:69], v[64:65], v[64:65]
    v_pk_mov_b32 v[70:71], v[64:65], v[64:65]
    v_pk_mov_b32 v[72:73], v[64:65], v[64:65]
    v_pk_mov_b32 v[74:75], v[64:65], v[64:65]
    v_pk_mov_b32 v[76:77], v[64:65], v[64:65]
    v_pk_mov_b32 v[78:79], v[64:65], v[64:65]
    v_mov_b32 v96, 0
    v_mov_b32 v97, 0
    v_mov_b32 v98, 0
    v_mov_b32 v99, 0
    v_mov_b32 v100, 0
    v_mov_b32 v101, 0
    v_mov_b32 v102, 0
    v_mov_b32 v103, 0
    v_mov_b32 v104, 0
    v_mov_b32 v105, 0
    v_mov_b32 v106, 0
    v_mov_b32 v107, 0
    v_mov_b32 v108, 0
    v_mov_b32 v109, 0
    v_mov_b32 v110, 0
    v_mov_b32 v111, 0
    v_mov_b32 v224, 0
    v_mov_b32 v225, 0
    v_mov_b32 v226, 0
    v_mov_b32 v227, 0
    v_mov_b32 v37, v36
    s_nop 1
    v_permlane32_swap_b32 v36, v37
    s_nop 1
    v_max_f32 v36, v36, v37
    v_sub_f32 v80, 0, v36
    v_sub_f32 v81, 0, v36
    v_pk_mov_b32 v[82:83], v[80:81], v[80:81]
    v_pk_mov_b32 v[84:85], v[80:81], v[80:81]
    v_pk_mov_b32 v[86:87], v[80:81], v[80:81]
    v_pk_mov_b32 v[88:89], v[80:81], v[80:81]
    v_pk_mov_b32 v[90:91], v[80:81], v[80:81]
    v_pk_mov_b32 v[92:93], v[80:81], v[80:81]
    v_pk_mov_b32 v[94:95], v[80:81], v[80:81]
    v_mov_b32 v112, 0
    v_mov_b32 v113, 0
    v_mov_b32 v114, 0
    v_mov_b32 v115, 0
    v_mov_b32 v116, 0
    v_mov_b32 v117, 0
    v_mov_b32 v118, 0
    v_mov_b32 v119, 0
    v_mov_b32 v120, 0
    v_mov_b32 v121, 0
    v_mov_b32 v122, 0
    v_mov_b32 v123, 0
    v_mov_b32 v124, 0
    v_mov_b32 v125, 0
    v_mov_b32 v126, 0
    v_mov_b32 v127, 0
    v_mov_b32 v228, 0
    v_mov_b32 v229, 0
    v_mov_b32 v230, 0
    v_mov_b32 v231, 0
    s_mov_b32 s31, 0
L_fb_loop:
    buffer_load_dwordx4 v[192:195], v249, s[12:15], s31 offen
    buffer_load_dwordx4 v[196:199], v249, s[12:15], s31 offen offset:32
    s_mov_b32 m0, s32
    s_nop 0
    buffer_load_dwordx4 v246, s[16:19], s31 offen lds
    buffer_load_dwordx4 v246, s[16:19], s31 offen offset:1024 lds
    s_waitcnt vmcnt(0)
    ds_read_b64_tr_b16 v[208:209], v250 offset:0
    ds_read_b64_tr_b16 v[210:211], v250 offset:256
    ds_read_b64_tr_b16 v[212:213], v250 offset:1024
    ds_read_b64_tr_b16 v[214:215], v250 offset:1280
    v_mfma_f32_32x32x16_bf16 v[0:15], v[192:195], v[160:163], v[64:79]
    v_mfma_f32_32x32x16_bf16 v[0:15], v[196:199], v[164:167], v[0:15]
    v_mfma_f32_32x32x16_bf16 v[16:31], v[192:195], v[168:171], v[80:95]
    v_mfma_f32_32x32x16_bf16 v[16:31], v[196:199], v[172:175], v[16:31]
    s_nop 15
    v_exp_f32 v0, v0
    v_exp_f32 v1, v1
    v_exp_f32 v2, v2
    v_exp_f32 v3, v3
    v_exp_f32 v4, v4
    v_exp_f32 v5, v5
    v_exp_f32 v6, v6
    v_exp_f32 v7, v7
    v_exp_f32 v8, v8
    v_exp_f32 v9, v9
    v_exp_f32 v10, v10
    v_exp_f32 v11, v11
    v_exp_f32 v12, v12
    v_exp_f32 v13, v13
    v_exp_f32 v14, v14
    v_exp_f32 v15, v15
    v_exp_f32 v16, v16
    v_exp_f32 v17, v17
    v_exp_f32 v18, v18
    v_exp_f32 v19, v19
    v_exp_f32 v20, v20
    v_exp_f32 v21, v21
    v_exp_f32 v22, v22
    v_exp_f32 v23, v23
    v_exp_f32 v24, v24
    v_exp_f32 v25, v25
    v_exp_f32 v26, v26
    v_exp_f32 v27, v27
    v_exp_f32 v28, v28
    v_exp_f32 v29, v29
    v_exp_f32 v30, v30
    v_exp_f32 v31, v31
    s_waitcnt lgkmcnt(0)
    s_nop 1
    v_smfmac_f32_32x32x32_bf16 v[96:111], v[208:211], v[0:7], v244
    v_smfmac_f32_32x32x32_bf16 v[96:111], v[212:215], v[8:15], v244
    v_smfmac_f32_16x16x64_bf16 v[224:227], v[240:243], v[0:7], v244
    v_smfmac_f32_16x16x64_bf16 v[224:227], v[240:243], v[8:15], v244
    v_smfmac_f32_32x32x32_bf16 v[112:127], v[208:211], v[16:23], v244
    v_smfmac_f32_32x32x32_bf16 v[112:127], v[212:215], v[24:31], v244
    v_smfmac_f32_16x16x64_bf16 v[228:231], v[240:243], v[16:23], v244
    v_smfmac_f32_16x16x64_bf16 v[228:231], v[240:243], v[24:31], v244
    s_add_u32 s31, s31, 2048
    s_cmp_lt_u32 s31, 131072
    s_cbranch_scc1 L_fb_loop
    s_nop 15
    s_nop 3
    v_mov_b32 v225, v224
    s_nop 1
    v_permlane32_swap_b32 v224, v225
    s_nop 0
    v_rcp_f32 v252, v224
    v_rcp_f32 v253, v224
    s_nop 0
    v_pk_mul_f32 v[96:97], v[96:97], v[252:253]
    v_pk_mul_f32 v[98:99], v[98:99], v[252:253]
    v_pk_mul_f32 v[100:101], v[100:101], v[252:253]
    v_pk_mul_f32 v[102:103], v[102:103], v[252:253]
    v_pk_mul_f32 v[104:105], v[104:105], v[252:253]
    v_pk_mul_f32 v[106:107], v[106:107], v[252:253]
    v_pk_mul_f32 v[108:109], v[108:109], v[252:253]
    v_pk_mul_f32 v[110:111], v[110:111], v[252:253]
    v_cvt_pk_bf16_f32 v32, v96, v97
    v_cvt_pk_bf16_f32 v33, v98, v99
    v_cvt_pk_bf16_f32 v34, v100, v101
    v_cvt_pk_bf16_f32 v35, v102, v103
    v_cvt_pk_bf16_f32 v36, v104, v105
    v_cvt_pk_bf16_f32 v37, v106, v107
    v_cvt_pk_bf16_f32 v38, v108, v109
    v_cvt_pk_bf16_f32 v39, v110, v111
    s_nop 1
    v_permlane32_swap_b32 v32, v34
    v_permlane32_swap_b32 v33, v35
    v_permlane32_swap_b32 v36, v38
    v_permlane32_swap_b32 v37, v39
    s_nop 1
    v_permlane16_swap_b32 v32, v36
    v_permlane16_swap_b32 v33, v37
    v_permlane16_swap_b32 v34, v38
    v_permlane16_swap_b32 v35, v39
    s_nop 0
    buffer_store_dwordx4 v[32:35], v248, s[24:27], s41 offen offset:0
    buffer_store_dwordx4 v[36:39], v248, s[24:27], s41 offen offset:1024
    v_mov_b32 v229, v228
    s_nop 1
    v_permlane32_swap_b32 v228, v229
    s_nop 0
    v_rcp_f32 v254, v228
    v_rcp_f32 v255, v228
    s_nop 0
    v_pk_mul_f32 v[112:113], v[112:113], v[254:255]
    v_pk_mul_f32 v[114:115], v[114:115], v[254:255]
    v_pk_mul_f32 v[116:117], v[116:117], v[254:255]
    v_pk_mul_f32 v[118:119], v[118:119], v[254:255]
    v_pk_mul_f32 v[120:121], v[120:121], v[254:255]
    v_pk_mul_f32 v[122:123], v[122:123], v[254:255]
    v_pk_mul_f32 v[124:125], v[124:125], v[254:255]
    v_pk_mul_f32 v[126:127], v[126:127], v[254:255]
    v_cvt_pk_bf16_f32 v40, v112, v113
    v_cvt_pk_bf16_f32 v41, v114, v115
    v_cvt_pk_bf16_f32 v42, v116, v117
    v_cvt_pk_bf16_f32 v43, v118, v119
    v_cvt_pk_bf16_f32 v44, v120, v121
    v_cvt_pk_bf16_f32 v45, v122, v123
    v_cvt_pk_bf16_f32 v46, v124, v125
    v_cvt_pk_bf16_f32 v47, v126, v127
    s_nop 1
    v_permlane32_swap_b32 v40, v42
    v_permlane32_swap_b32 v41, v43
    v_permlane32_swap_b32 v44, v46
    v_permlane32_swap_b32 v45, v47
    s_nop 1
    v_permlane16_swap_b32 v40, v44
    v_permlane16_swap_b32 v41, v45
    v_permlane16_swap_b32 v42, v46
    v_permlane16_swap_b32 v43, v47
    s_nop 0
    buffer_store_dwordx4 v[40:43], v248, s[24:27], s41 offen offset:2048
    buffer_store_dwordx4 v[44:47], v248, s[24:27], s41 offen offset:3072
    s_waitcnt vmcnt(0)
L_fb_next:
    s_lshr_b32 s40, s40, 1
    s_add_u32 s41, s41, 4096
    s_cmp_lt_u32 s41, 8192
    s_cbranch_scc1 L_fb_pair
    s_branch L_done
L_end:
    s_endpgm
.section .rodata,"a"
.p2align 6
.amdhsa_kernel standalone__fused_io_aware_attn__prompt_kernel
  .amdhsa_next_free_vgpr 256
  .amdhsa_next_free_sgpr 48
  .amdhsa_accum_offset 256
  .amdhsa_group_segment_fixed_size 0
  .amdhsa_kernarg_size 48
  .amdhsa_user_sgpr_count 2
  .amdhsa_user_sgpr_kernarg_segment_ptr 1
  .amdhsa_system_sgpr_workgroup_id_x 1
.end_amdhsa_kernel
```
